```python
import torch

def _softmax(x, axis=-1):
    return torch.softmax(x, dim=axis)
def _gelu(x):
    return torch.nn.functional.gelu(x, approximate="tanh")
def _silu(x):
    return torch.nn.functional.silu(x)
def _sigmoid(x):
    return torch.sigmoid(x)
def _layernorm(x, axis=-1, eps=1e-5):
    m = x.mean(dim=axis, keepdim=True)
    v = x.var(dim=axis, keepdim=True, unbiased=False)
    return (x - m) / torch.sqrt(v + eps)
def _scatter_add(tgt, idx, src, axis=0):
    return tgt.clone().index_add_(axis, idx, src)
def _segment_sum(src, seg, n):
    out = torch.zeros((n,) + src.shape[1:], dtype=src.dtype)
    return out.index_add_(0, seg, src)
def _pad(x, pw):
    flat = tuple(v for pair in reversed(pw) for v in pair)
    return torch.nn.functional.pad(x, flat)

kernel_name = 'sequential_preLN__grouped_kv_mqa__dense_activation_silu__prompt'

def setup_inputs():

    _w = (lambda a: (lambda t: t.to(torch.bfloat16) if t.is_floating_point() else t)(torch.as_tensor(a)))
    def _A_setup():
        B, S, D, H = 1, 2048, 640, 32
        Dh = D // H
        return {
            "x": _w((lambda *s: torch.randn(*s, dtype=torch.bfloat16) * 0.05)(B, S, D)),
            "wq": _w((lambda *s: torch.randn(*s, dtype=torch.bfloat16) * 0.05)(D, H * Dh)),
            "wk": _w((lambda *s: torch.randn(*s, dtype=torch.bfloat16) * 0.05)(D, Dh)),
            "wv": _w((lambda *s: torch.randn(*s, dtype=torch.bfloat16) * 0.05)(D, Dh)),
            "wo": _w((lambda *s: torch.randn(*s, dtype=torch.bfloat16) * 0.05)(H * Dh, D)),
        }
    _A_in = _A_setup()

    def _B_setup():
        B, S, D, F = 1, 2048, 640, 1728
        return {
            "x": _w((lambda *s: torch.randn(*s, dtype=torch.bfloat16) * 0.05)(B, S, D)),
            "w1": _w((lambda *s: torch.randn(*s, dtype=torch.bfloat16) * 0.8)(D, F) * (D ** -0.5)),
            "w2": _w((lambda *s: torch.randn(*s, dtype=torch.bfloat16) * 0.8)(F, D) * (F ** -0.5)),
        }
    _B_in = _B_setup()

    return {
        "A_x": _A_in["x"],
        "A_wq": _A_in["wq"],
        "A_wk": _A_in["wk"],
        "A_wv": _A_in["wv"],
        "A_wo": _A_in["wo"],
        "B_x": _B_in["x"],
        "B_w1": _B_in["w1"],
        "B_w2": _B_in["w2"],
    }

def reference(A_x, A_wq, A_wk, A_wv, A_wo, B_x, B_w1, B_w2):
    def _A_ref(x, wq, wk, wv, wo):
        B, S, D = x.shape
        H = 32
        Dh = D // H
        q = (lambda x, *d: x.permute(*d))((x @ wq).reshape(B, S, H, Dh), 0, 2, 1, 3)
        k = x @ wk
        v = x @ wv
        scores = torch.einsum("bhqd,bkd->bhqk", q, k) * (Dh ** -0.5)
        p = _softmax(scores, axis=-1)
        o = torch.einsum("bhqk,bkd->bhqd", p, v)
        return (lambda x, *d: x.permute(*d))(o, 0, 2, 1, 3).reshape(B, S, H * Dh) @ wo

    def _B_ref(x, w1, w2):
        h = torch.einsum("bsd,df->bsf", x, w1)
        h = _silu(h)
        out = torch.einsum("bsf,fd->bsd", h, w2)
        return out

    x = A_x
    h = x + _A_ref(_layernorm(x, axis=-1), A_wq, A_wk, A_wv, A_wo)
    h2 = h + _B_ref(_layernorm(h, axis=-1), B_w1, B_w2)
    return h2
```

```asm
; @launch grid=(256,1,1) block=(576,1,1) lds=163840
.amdgcn_target "amdgcn-amd-amdhsa--gfx950"
.text
.globl sequential_preLN__grouped_kv_mqa__dense_activation_silu__prompt_kernel
.p2align 8
.type sequential_preLN__grouped_kv_mqa__dense_activation_silu__prompt_kernel,@function
sequential_preLN__grouped_kv_mqa__dense_activation_silu__prompt_kernel:
    s_cmp_ge_u32 s2, 256
    s_cbranch_scc1 sequential_preLN__grouped_kv_mqa__dense_activation_silu__prompt_kernel_end
    s_load_dwordx8 s[48:55], s[0:1], 0
    s_load_dwordx4 s[56:59], s[0:1], 72
    s_load_dwordx2 s[82:83], s[0:1], 32
    s_load_dwordx4 s[84:87], s[0:1], 48
    s_load_dwordx2 s[80:81], s[0:1], 64
    s_load_dwordx2 s[78:79], s[0:1], 0
    s_load_dwordx2 s[76:77], s[0:1], 80
    v_and_b32 v1, 63, v0
    v_lshrrev_b32 v2, 6, v0
    s_and_b32 s38, s2, 7
    v_readfirstlane_b32 s3, v2
    s_lshr_b32 s39, s2, 3
    s_lshl_b32 s40, s38, 2
    s_lshr_b32 s41, s39, 3
    s_add_u32 s24, s41, s40
    s_and_b32 s25, s39, 7
    s_and_b32 s67, s3, 3
    s_lshl_b32 s45, s24, 2
    s_add_u32 s45, s45, s67
    s_cmp_lt_u32 s3, 4
    s_cbranch_scc1 sequential_preLN__grouped_kv_mqa__dense_activation_silu__prompt_kernel_A_comp
    s_cmp_lt_u32 s3, 8
    s_cbranch_scc1 sequential_preLN__grouped_kv_mqa__dense_activation_silu__prompt_kernel_A_load
    s_cmp_gt_u32 s2, 15
    s_cbranch_scc1 sequential_preLN__grouped_kv_mqa__dense_activation_silu__prompt_kernel_A_ncp
    s_getpc_b64 s[14:15]
sequential_preLN__grouped_kv_mqa__dense_activation_silu__prompt_kernel_A_pc:
    v_lshlrev_b32 v12, 7, v1
    v_mov_b32 v13, s15
    v_add_co_u32 v12, vcc, s14, v12
    s_nop 1
    v_addc_co_u32 v13, vcc, 0, v13, vcc
    global_load_dword v14, v[12:13], off
    v_add_co_u32 v12, vcc, 0x2000, v12
    s_nop 1
    v_addc_co_u32 v13, vcc, 0, v13, vcc
    global_load_dword v15, v[12:13], off
    v_add_co_u32 v12, vcc, 0x2000, v12
    s_nop 1
    v_addc_co_u32 v13, vcc, 0, v13, vcc
    global_load_dword v16, v[12:13], off
    v_add_co_u32 v12, vcc, 0x2000, v12
    s_nop 1
    v_addc_co_u32 v13, vcc, 0, v13, vcc
    v_lshlrev_b32 v20, 7, v1
    v_cmp_gt_u32 vcc, sequential_preLN__grouped_kv_mqa__dense_activation_silu__prompt_kernel_end-sequential_preLN__grouped_kv_mqa__dense_activation_silu__prompt_kernel_A_pc-24576, v20
    s_and_saveexec_b64 s[16:17], vcc
    global_load_dword v17, v[12:13], off
    s_mov_b64 exec, -1
sequential_preLN__grouped_kv_mqa__dense_activation_silu__prompt_kernel_A_ncp:
    s_memrealtime s[12:13]
    s_waitcnt lgkmcnt(0)
    s_mov_b32 s20, s56
    s_mov_b32 s21, s57
    s_mov_b32 s22, 256
    s_mov_b32 s23, 0x00020000
    s_or_b32 s12, s12, 1
    v_lshlrev_b32 v2, 7, v1
    v_mov_b32 v8, s12
    s_cmp_lg_u32 s2, 0
    s_cbranch_scc1 sequential_preLN__grouped_kv_mqa__dense_activation_silu__prompt_kernel_A_tk1
    s_mov_b64 exec, 3
    buffer_store_dword v8, v2, s[20:23], 0 offen sc1
sequential_preLN__grouped_kv_mqa__dense_activation_silu__prompt_kernel_A_tk1:
    s_mov_b64 exec, 1
    s_and_b32 s12, s2, 1
    s_lshl_b32 s12, s12, 7
    s_mov_b32 s13, 524288
    s_barrier
    s_barrier
    s_barrier
sequential_preLN__grouped_kv_mqa__dense_activation_silu__prompt_kernel_A_tk2:
    buffer_load_dword v8, v2, s[20:23], s12 offen sc1
    s_waitcnt vmcnt(0)
    v_readfirstlane_b32 s100, v8
    s_sub_u32 s13, s13, 1
    s_cbranch_scc1 sequential_preLN__grouped_kv_mqa__dense_activation_silu__prompt_kernel_A_tk3
    s_cmp_eq_u32 s100, 0
    s_cbranch_scc1 sequential_preLN__grouped_kv_mqa__dense_activation_silu__prompt_kernel_A_tk2
sequential_preLN__grouped_kv_mqa__dense_activation_silu__prompt_kernel_A_tk3:
    v_mov_b32 v2, 143808
    ds_write_b32 v2, v8
    s_mov_b64 exec, -1
    s_mov_b32 s20, s58
    s_mov_b32 s21, s59
    s_mov_b32 s22, 25165824
    s_mov_b32 s23, 0x00020000
    s_lshl_b32 s38, s24, 2
    s_add_u32 s38, s38, s25
    s_lshl_b32 s38, s38, 7
    s_add_u32 s38, s38, 23592960
    v_lshlrev_b32 v3, 14, v1
    v_mov_b32 v2, 143824
    s_waitcnt lgkmcnt(0)
    s_barrier
    s_barrier
    s_barrier
    s_barrier
    s_cmp_ge_u32 s25, 4
    s_cbranch_scc1 sequential_preLN__grouped_kv_mqa__dense_activation_silu__prompt_kernel_A_np
    ds_read_b128 v[12:15], v2
    s_waitcnt lgkmcnt(0)
    v_max_f32 v12, v12, v13
    v_max3_f32 v12, v12, v14, v15
    v_mov_b32 v13, s100
    s_cmp_ge_u32 s25, 2
    s_cbranch_scc0 sequential_preLN__grouped_kv_mqa__dense_activation_silu__prompt_kernel_A_pk
    v_mov_b32 v12, 0
sequential_preLN__grouped_kv_mqa__dense_activation_silu__prompt_kernel_A_pk:
    s_mov_b64 exec, 0xff
    buffer_store_dwordx2 v[12:13], v3, s[20:23], s38 offen sc1
    s_mov_b64 exec, -1
sequential_preLN__grouped_kv_mqa__dense_activation_silu__prompt_kernel_A_np:
    s_barrier
    s_barrier
    s_barrier
    s_barrier
    s_barrier
    s_branch sequential_preLN__grouped_kv_mqa__dense_activation_silu__prompt_kernel_M
sequential_preLN__grouped_kv_mqa__dense_activation_silu__prompt_kernel_A_load:
    s_mul_i32 s33, s41, 5
    s_lshr_b32 s33, s33, 1
    s_add_u32 s33, s33, s25
    s_cmp_ge_u32 s33, 10
    s_cselect_b32 s38, 10, 0
    s_sub_u32 s33, s33, s38
    s_mul_i32 s26, s45, 20480
    s_lshl_b32 s38, s33, 7
    s_add_u32 s26, s26, s38
    v_lshrrev_b32 v2, 3, v1
    v_and_b32 v4, 7, v1
    v_xor_b32 v4, v4, v2
    v_mul_u32_u24 v6, 1280, v2
    v_lshl_add_u32 v6, v4, 4, v6
    v_add_u32 v11, 9216, v6
    s_lshr_b32 s38, s67, 1
    s_lshl_b32 s38, s38, 5
    s_and_b32 s39, s67, 1
    s_lshl_b32 s39, s39, 2
    s_add_u32 s38, s38, s39
    s_lshl_b32 s39, s33, 6
    s_add_u32 s38, s38, s39
    s_mul_i32 s27, s38, 1280
    s_mul_i32 s39, s25, 160
    s_add_u32 s27, s27, s39
    s_mul_i32 s28, s38, 40
    s_and_b32 s39, s25, 1
    s_lshl_b32 s39, s39, 3
    s_add_u32 s28, s28, s39
    v_bfe_u32 v4, v1, 1, 4
    v_and_b32 v2, 12, v4
    v_add_u32 v4, v4, v2
    v_mul_u32_u24 v4, 40, v4
    v_and_b32 v5, 1, v1
    v_lshl_add_u32 v10, v5, 4, v4
    s_lshl_b32 s64, s67, 11
    s_lshl_b32 s66, s67, 9
    s_add_u32 s66, s66, 81920
    s_mov_b32 s31, s33
    s_mov_b32 s30, 0
    s_waitcnt lgkmcnt(0)
    s_mov_b32 s4, s48
    s_mov_b32 s5, s49
    s_mov_b32 s6, 2621440
    s_mov_b32 s7, 0x00020000
    s_bitcmp1_b32 s25, 1
    s_cselect_b32 s12, s54, s52
    s_cselect_b32 s13, s55, s53
    s_mov_b32 s14, 25600
    s_mov_b32 s15, 0x00020000
sequential_preLN__grouped_kv_mqa__dense_activation_silu__prompt_kernel_A_lx:
    s_mov_b32 m0, s64
    s_add_u32 s31, s31, 1
    buffer_load_dwordx4 v6, s[4:7], s26 offen lds
    buffer_load_dwordx4 v11, s[4:7], s26 offen offset:1024 lds
    s_mov_b32 m0, s66
    s_mov_b32 exec_hi, 0
    buffer_load_dwordx4 v10, s[12:15], s28 offen lds
    s_mov_b32 exec_hi, -1
    s_cmp_eq_u32 s31, 10
    s_cselect_b32 s38, -9, 1
    s_cselect_b32 s31, 0, s31
    s_lshl_b32 s41, s38, 7
    s_add_u32 s26, s26, s41
    s_mul_i32 s41, s38, 2560
    s_add_u32 s28, s28, s41
    s_add_u32 s64, s64, 8192
    s_add_u32 s66, s66, 2048
    s_add_u32 s30, s30, 1
    s_cmp_lt_u32 s30, 10
    s_cbranch_scc1 sequential_preLN__grouped_kv_mqa__dense_activation_silu__prompt_kernel_A_lx
    v_mul_u32_u24 v4, 205, v1
    v_lshrrev_b32 v4, 11, v4
    v_mul_u32_u24 v5, 10, v4
    v_sub_u32 v5, v1, v5
    v_and_b32 v2, 12, v4
    v_add_u32 v4, v4, v2
    v_mul_u32_u24 v4, 1280, v4
    v_lshl_add_u32 v7, v5, 4, v4
    v_add_u32 v2, 64, v1
    v_mul_u32_u24 v4, 205, v2
    v_lshrrev_b32 v4, 11, v4
    v_mul_u32_u24 v5, 10, v4
    v_sub_u32 v5, v2, v5
    v_and_b32 v2, 12, v4
    v_add_u32 v4, v4, v2
    v_mul_u32_u24 v4, 1280, v4
    v_lshl_add_u32 v8, v5, 4, v4
    v_subrev_u32 v8, 1024, v8
    v_add_u32 v2, 128, v1
    v_mul_u32_u24 v4, 205, v2
    v_lshrrev_b32 v4, 11, v4
    v_mul_u32_u24 v5, 10, v4
    v_sub_u32 v5, v2, v5
    v_and_b32 v2, 12, v4
    v_add_u32 v4, v4, v2
    v_mul_u32_u24 v4, 1280, v4
    v_lshl_add_u32 v9, v5, 4, v4
    v_subrev_u32 v9, 2048, v9
    s_mul_i32 s65, s67, 2560
    s_add_u32 s65, s65, 102400
    s_mov_b32 s8, s50
    s_mov_b32 s9, s51
    s_mov_b32 s10, 819200
    s_mov_b32 s11, 0x00020000
    s_add_u32 m0, s65, 0
    s_add_u32 s31, s31, 1
    buffer_load_dwordx4 v7, s[8:11], s27 offen lds
    buffer_load_dwordx4 v8, s[8:11], s27 offen offset:1024 lds
    s_mov_b32 exec_hi, 0
    buffer_load_dwordx4 v9, s[8:11], s27 offen offset:2048 lds
    s_mov_b32 exec_hi, -1
    s_cmp_eq_u32 s31, 10
    s_cselect_b32 s38, -737280, 0
    s_cselect_b32 s31, 0, s31
    s_cselect_b32 s38, s38, 81920
    s_add_u32 s27, s27, s38
    s_add_u32 m0, s65, 10240
    s_add_u32 s31, s31, 1
    buffer_load_dwordx4 v7, s[8:11], s27 offen lds
    buffer_load_dwordx4 v8, s[8:11], s27 offen offset:1024 lds
    s_mov_b32 exec_hi, 0
    buffer_load_dwordx4 v9, s[8:11], s27 offen offset:2048 lds
    s_mov_b32 exec_hi, -1
    s_cmp_eq_u32 s31, 10
    s_cselect_b32 s38, -737280, 0
    s_cselect_b32 s31, 0, s31
    s_cselect_b32 s38, s38, 81920
    s_add_u32 s27, s27, s38
    s_waitcnt vmcnt(30)
    s_barrier
    s_add_u32 m0, s65, 20480
    s_add_u32 s31, s31, 1
    buffer_load_dwordx4 v7, s[8:11], s27 offen lds
    buffer_load_dwordx4 v8, s[8:11], s27 offen offset:1024 lds
    s_mov_b32 exec_hi, 0
    buffer_load_dwordx4 v9, s[8:11], s27 offen offset:2048 lds
    s_mov_b32 exec_hi, -1
    s_cmp_eq_u32 s31, 10
    s_cselect_b32 s38, -737280, 0
    s_cselect_b32 s31, 0, s31
    s_cselect_b32 s38, s38, 81920
    s_add_u32 s27, s27, s38
    s_waitcnt vmcnt(27)
    s_barrier
    s_add_u32 m0, s65, 30720
    s_add_u32 s31, s31, 1
    buffer_load_dwordx4 v7, s[8:11], s27 offen lds
    buffer_load_dwordx4 v8, s[8:11], s27 offen offset:1024 lds
    s_mov_b32 exec_hi, 0
    buffer_load_dwordx4 v9, s[8:11], s27 offen offset:2048 lds
    s_mov_b32 exec_hi, -1
    s_cmp_eq_u32 s31, 10
    s_cselect_b32 s38, -737280, 0
    s_cselect_b32 s31, 0, s31
    s_cselect_b32 s38, s38, 81920
    s_add_u32 s27, s27, s38
    s_waitcnt vmcnt(24)
    s_barrier
    s_waitcnt vmcnt(18)
    s_barrier
    s_waitcnt vmcnt(12)
    s_barrier
    s_waitcnt vmcnt(9)
    s_barrier
    s_waitcnt vmcnt(6)
    s_barrier
    s_add_u32 m0, s65, 0
    s_add_u32 s31, s31, 1
    buffer_load_dwordx4 v7, s[8:11], s27 offen lds
    buffer_load_dwordx4 v8, s[8:11], s27 offen offset:1024 lds
    s_mov_b32 exec_hi, 0
    buffer_load_dwordx4 v9, s[8:11], s27 offen offset:2048 lds
    s_mov_b32 exec_hi, -1
    s_cmp_eq_u32 s31, 10
    s_cselect_b32 s38, -737280, 0
    s_cselect_b32 s31, 0, s31
    s_cselect_b32 s38, s38, 81920
    s_add_u32 s27, s27, s38
    s_waitcnt vmcnt(6)
    s_barrier
    s_add_u32 m0, s65, 10240
    s_add_u32 s31, s31, 1
    buffer_load_dwordx4 v7, s[8:11], s27 offen lds
    buffer_load_dwordx4 v8, s[8:11], s27 offen offset:1024 lds
    s_mov_b32 exec_hi, 0
    buffer_load_dwordx4 v9, s[8:11], s27 offen offset:2048 lds
    s_mov_b32 exec_hi, -1
    s_cmp_eq_u32 s31, 10
    s_cselect_b32 s38, -737280, 0
    s_cselect_b32 s31, 0, s31
    s_cselect_b32 s38, s38, 81920
    s_add_u32 s27, s27, s38
    s_waitcnt vmcnt(6)
    s_barrier
    s_add_u32 m0, s65, 20480
    s_add_u32 s31, s31, 1
    buffer_load_dwordx4 v7, s[8:11], s27 offen lds
    buffer_load_dwordx4 v8, s[8:11], s27 offen offset:1024 lds
    s_mov_b32 exec_hi, 0
    buffer_load_dwordx4 v9, s[8:11], s27 offen offset:2048 lds
    s_mov_b32 exec_hi, -1
    s_cmp_eq_u32 s31, 10
    s_cselect_b32 s38, -737280, 0
    s_cselect_b32 s31, 0, s31
    s_cselect_b32 s38, s38, 81920
    s_add_u32 s27, s27, s38
    s_waitcnt vmcnt(6)
    s_barrier
    s_add_u32 m0, s65, 30720
    s_add_u32 s31, s31, 1
    buffer_load_dwordx4 v7, s[8:11], s27 offen lds
    buffer_load_dwordx4 v8, s[8:11], s27 offen offset:1024 lds
    s_mov_b32 exec_hi, 0
    buffer_load_dwordx4 v9, s[8:11], s27 offen offset:2048 lds
    s_mov_b32 exec_hi, -1
    s_cmp_eq_u32 s31, 10
    s_cselect_b32 s38, -737280, 0
    s_cselect_b32 s31, 0, s31
    s_cselect_b32 s38, s38, 81920
    s_add_u32 s27, s27, s38
    s_waitcnt vmcnt(6)
    s_barrier
    s_add_u32 m0, s65, 0
    s_add_u32 s31, s31, 1
    buffer_load_dwordx4 v7, s[8:11], s27 offen lds
    buffer_load_dwordx4 v8, s[8:11], s27 offen offset:1024 lds
    s_mov_b32 exec_hi, 0
    buffer_load_dwordx4 v9, s[8:11], s27 offen offset:2048 lds
    s_mov_b32 exec_hi, -1
    s_cmp_eq_u32 s31, 10
    s_cselect_b32 s38, -737280, 0
    s_cselect_b32 s31, 0, s31
    s_cselect_b32 s38, s38, 81920
    s_add_u32 s27, s27, s38
    s_waitcnt vmcnt(6)
    s_barrier
    s_add_u32 m0, s65, 10240
    s_add_u32 s31, s31, 1
    buffer_load_dwordx4 v7, s[8:11], s27 offen lds
    buffer_load_dwordx4 v8, s[8:11], s27 offen offset:1024 lds
    s_mov_b32 exec_hi, 0
    buffer_load_dwordx4 v9, s[8:11], s27 offen offset:2048 lds
    s_mov_b32 exec_hi, -1
    s_cmp_eq_u32 s31, 10
    s_cselect_b32 s38, -737280, 0
    s_cselect_b32 s31, 0, s31
    s_cselect_b32 s38, s38, 81920
    s_add_u32 s27, s27, s38
    s_waitcnt vmcnt(6)
    s_barrier
    s_waitcnt vmcnt(3)
    s_barrier
    s_waitcnt vmcnt(0)
    s_barrier
    s_barrier
    v_mov_b32 v2, 143808
    s_barrier
    ds_read_b32 v3, v2
    s_waitcnt vmcnt(0) lgkmcnt(0)
    v_readfirstlane_b32 s100, v3
    s_barrier
    s_branch sequential_preLN__grouped_kv_mqa__dense_activation_silu__prompt_kernel_M
sequential_preLN__grouped_kv_mqa__dense_activation_silu__prompt_kernel_A_comp:
    s_mul_i32 s42, s25, 5
    v_lshrrev_b32 v9, 4, v1
    v_and_b32 v3, 15, v1
    s_lshl_b32 s38, s3, 11
    v_and_b32 v2, 7, v3
    v_xor_b32 v2, v2, v9
    v_lshlrev_b32 v2, 4, v2
    v_lshl_add_u32 v2, v3, 7, v2
    v_add_u32 v6, s38, v2
    v_xor_b32 v7, 64, v6
    v_lshrrev_b32 v2, 2, v1
    v_and_b32 v4, 3, v1
    v_lshlrev_b32 v4, 3, v4
    v_mul_u32_u24 v5, 160, v2
    v_add3_u32 v5, v5, v4, s38
    v_subrev_u32 v5, s38, v5
    v_add_u32 v5, 102400, v5
    v_lshl_add_u32 v10, v2, 5, v4
    v_add_u32 v10, 81920, v10
    s_lshl_b32 s39, s3, 1
    s_add_u32 s70, s39, 0
    s_cmp_ge_u32 s70, 5
    s_cselect_b32 s38, 5, 0
    s_sub_u32 s70, s70, s38
    s_cmp_ge_u32 s70, 5
    s_cselect_b32 s38, 5, 0
    s_sub_u32 s70, s70, s38
    s_lshl_b32 s38, s70, 5
    v_add_u32 v11, s38, v5
    s_add_u32 s71, s39, 1
    s_cmp_ge_u32 s71, 5
    s_cselect_b32 s38, 5, 0
    s_sub_u32 s71, s71, s38
    s_cmp_ge_u32 s71, 5
    s_cselect_b32 s38, 5, 0
    s_sub_u32 s71, s71, s38
    s_lshl_b32 s38, s71, 5
    v_add_u32 v12, s38, v5
    s_add_u32 s72, s39, 2
    s_cmp_ge_u32 s72, 5
    s_cselect_b32 s38, 5, 0
    s_sub_u32 s72, s72, s38
    s_cmp_ge_u32 s72, 5
    s_cselect_b32 s38, 5, 0
    s_sub_u32 s72, s72, s38
    s_lshl_b32 s38, s72, 5
    v_add_u32 v13, s38, v5
    s_add_u32 s73, s39, 3
    s_cmp_ge_u32 s73, 5
    s_cselect_b32 s38, 5, 0
    s_sub_u32 s73, s73, s38
    s_cmp_ge_u32 s73, 5
    s_cselect_b32 s38, 5, 0
    s_sub_u32 s73, s73, s38
    s_lshl_b32 s38, s73, 5
    v_add_u32 v14, s38, v5
    s_add_u32 s74, s39, 4
    s_cmp_ge_u32 s74, 5
    s_cselect_b32 s38, 5, 0
    s_sub_u32 s74, s74, s38
    s_cmp_ge_u32 s74, 5
    s_cselect_b32 s38, 5, 0
    s_sub_u32 s74, s74, s38
    s_lshl_b32 s38, s74, 5
    v_add_u32 v15, s38, v5
    v_mul_u32_u24 v163, 1280, v3
    v_lshl_add_u32 v163, v9, 3, v163
    s_mul_i32 s47, s45, 20480
    s_lshl_b32 s39, s42, 5
    s_add_u32 s47, s47, s39
    s_mul_i32 s38, s3, 2688
    s_add_u32 s38, s38, 112640
    v_mul_u32_u24 v8, 168, v3
    v_lshl_add_u32 v8, v9, 3, v8
    v_add_u32 v8, s38, v8
    s_mov_b32 s44, 0x3f803f80
    v_mov_b32 v16, s44
    v_mov_b32 v17, s44
    v_mov_b32 v18, s44
    v_mov_b32 v19, s44
    v_mov_b32 v20, 0
    v_mov_b32 v21, 0
    v_mov_b32 v22, 0
    v_mov_b32 v23, 0
    v_mov_b32 v24, 0
    v_mov_b32 v25, 0
    v_mov_b32 v26, 0
    v_mov_b32 v27, 0
    v_mov_b32 v28, 0
    v_mov_b32 v29, 0
    v_mov_b32 v30, 0
    v_mov_b32 v31, 0
    v_mov_b32 v32, 0
    v_mov_b32 v33, 0
    v_mov_b32 v34, 0
    v_mov_b32 v35, 0
    v_mov_b32 v36, 0
    v_mov_b32 v37, 0
    v_mov_b32 v38, 0
    v_mov_b32 v39, 0
    v_mov_b32 v136, 0
    v_mov_b32 v137, 0
    v_mov_b32 v138, 0
    v_mov_b32 v139, 0
    v_mov_b32 v140, 0
    v_mov_b32 v141, 0
    v_mov_b32 v142, 0
    v_mov_b32 v143, 0
    v_mov_b32 v144, 0
    v_mov_b32 v145, 0
    v_mov_b32 v146, 0
    v_mov_b32 v147, 0
    v_mov_b32 v148, 0
    v_mov_b32 v149, 0
    v_mov_b32 v150, 0
    v_mov_b32 v151, 0
    v_mov_b32 v152, 0
    v_mov_b32 v153, 0
    v_mov_b32 v154, 0
    v_mov_b32 v155, 0
    v_mov_b32 v156, 0
    v_mov_b32 v157, 0
    v_mov_b32 v158, 0
    v_mov_b32 v159, 0
    s_mov_b32 s30, 0
    s_mov_b32 s29, 0
    s_waitcnt lgkmcnt(0)
    s_mov_b32 s20, s58
    s_mov_b32 s21, s59
    s_mov_b32 s22, 25165824
    s_mov_b32 s23, 0x00020000
sequential_preLN__grouped_kv_mqa__dense_activation_silu__prompt_kernel_A_p1:
    s_barrier
    ds_read_b128 v[40:43], v6 offset:0
    ds_read_b64_tr_b16 v[44:45], v10 offset:0
    ds_read_b64_tr_b16 v[46:47], v10 offset:512
    ds_read_b128 v[48:51], v7 offset:0
    ds_read_b64_tr_b16 v[52:53], v10 offset:1024
    ds_read_b64_tr_b16 v[54:55], v10 offset:1536
    ds_read_b128 v[56:59], v6 offset:8192
    ds_read_b64_tr_b16 v[60:61], v10 offset:2048
    ds_read_b64_tr_b16 v[62:63], v10 offset:2560
    ds_read_b128 v[64:67], v7 offset:8192
    ds_read_b64_tr_b16 v[68:69], v10 offset:3072
    ds_read_b64_tr_b16 v[70:71], v10 offset:3584
    v_add_u32 v6, 16384, v6
    v_add_u32 v7, 16384, v7
    v_add_u32 v10, 4096, v10
    s_waitcnt lgkmcnt(9)
    v_mfma_f32_16x16x32_bf16 v[20:23], v[16:19], v[40:43], v[20:23]
    v_mfma_f32_16x16x32_bf16 v[24:27], v[40:43], v[40:43], v[24:27]
    v_mfma_f32_16x16x32_bf16 v[156:159], v[44:47], v[40:43], v[156:159]
    v_mfma_f32_16x16x32_bf16 v[36:39], v[44:47], v[16:19], v[36:39]
    s_waitcnt lgkmcnt(6)
    v_mfma_f32_16x16x32_bf16 v[20:23], v[16:19], v[48:51], v[20:23]
    v_mfma_f32_16x16x32_bf16 v[24:27], v[48:51], v[48:51], v[24:27]
    v_mfma_f32_16x16x32_bf16 v[156:159], v[52:55], v[48:51], v[156:159]
    v_mfma_f32_16x16x32_bf16 v[36:39], v[52:55], v[16:19], v[36:39]
    s_waitcnt lgkmcnt(3)
    v_mfma_f32_16x16x32_bf16 v[20:23], v[16:19], v[56:59], v[20:23]
    v_mfma_f32_16x16x32_bf16 v[24:27], v[56:59], v[56:59], v[24:27]
    v_mfma_f32_16x16x32_bf16 v[156:159], v[60:63], v[56:59], v[156:159]
    v_mfma_f32_16x16x32_bf16 v[36:39], v[60:63], v[16:19], v[36:39]
    s_waitcnt lgkmcnt(0)
    v_mfma_f32_16x16x32_bf16 v[20:23], v[16:19], v[64:67], v[20:23]
    v_mfma_f32_16x16x32_bf16 v[24:27], v[64:67], v[64:67], v[24:27]
    v_mfma_f32_16x16x32_bf16 v[156:159], v[68:71], v[64:67], v[156:159]
    v_mfma_f32_16x16x32_bf16 v[36:39], v[68:71], v[16:19], v[36:39]
    s_add_u32 s30, s30, 1
    s_cmp_lt_u32 s30, 5
    s_cbranch_scc1 sequential_preLN__grouped_kv_mqa__dense_activation_silu__prompt_kernel_A_p1
    v_subrev_u32 v6, 81920, v6
    v_subrev_u32 v7, 81920, v7
    v_and_b32 v3, 15, v1
    v_lshlrev_b32 v4, 2, v9
    v_sub_u32 v4, v3, v4
    v_mov_b32 v76, 0
    s_nop 1
    v_cmp_eq_u32 vcc, 0, v4
    s_nop 1
    v_cndmask_b32 v76, v76, v24, vcc
    v_cmp_eq_u32 vcc, 1, v4
    s_nop 1
    v_cndmask_b32 v76, v76, v25, vcc
    v_cmp_eq_u32 vcc, 2, v4
    s_nop 1
    v_cndmask_b32 v76, v76, v26, vcc
    v_cmp_eq_u32 vcc, 3, v4
    s_nop 1
    v_cndmask_b32 v76, v76, v27, vcc
    v_mov_b32 v77, v76
    s_nop 1
    v_permlane16_swap_b32 v76, v77
    s_nop 1
    v_add_f32 v76, v76, v77
    v_mov_b32 v77, v76
    s_nop 1
    v_permlane32_swap_b32 v76, v77
    s_nop 1
    v_add_f32 v76, v76, v77
    v_mul_f32 v160, 0x3acccccd, v20
    v_mul_f32 v76, 0x3acccccd, v76
    v_fma_f32 v76, -v160, v160, v76
    v_max_f32 v76, 0, v76
    v_add_f32 v76, 0x3727c5ac, v76
    v_rsq_f32 v161, v76
    s_mov_b32 s30, 0
    v_mul_f32 v162, 0x3ea52b5c, v161
    s_cmp_ge_u32 s25, 4
    s_cbranch_scc1 sequential_preLN__grouped_kv_mqa__dense_activation_silu__prompt_kernel_A_fin
    v_fma_f32 v156, -v160, v36, v156
    v_fma_f32 v157, -v160, v37, v157
    v_fma_f32 v158, -v160, v38, v158
    v_fma_f32 v159, -v160, v39, v159
    v_mul_f32 v156, v161, v156
    v_mul_f32 v157, v161, v157
    v_mul_f32 v158, v161, v158
    v_mul_f32 v159, v161, v159
    v_cvt_pk_bf16_f32 v164, v156, v157
    v_cvt_pk_bf16_f32 v165, v158, v159
    s_lshr_b32 s38, s45, 1
    s_mul_i32 s38, s38, 2560
    s_add_u32 s38, s38, 2621440
    s_and_b32 s39, s45, 1
    s_bitcmp1_b32 s25, 1
    s_cbranch_scc1 sequential_preLN__grouped_kv_mqa__dense_activation_silu__prompt_kernel_A_v
    v_mul_f32 v76, v156, v156
    v_fmac_f32 v76, v157, v157
    v_fmac_f32 v76, v158, v158
    v_fmac_f32 v76, v159, v159
    s_lshl_b32 s40, s3, 2
    s_add_u32 s40, s40, 143824
    v_mov_b32 v5, s40
    s_bitcmp1_b32 s25, 0
    s_cbranch_scc1 sequential_preLN__grouped_kv_mqa__dense_activation_silu__prompt_kernel_A_khi
    s_lshl_b32 s39, s39, 8
    s_add_u32 s38, s38, s39
    v_mov_b32 v166, v164
    v_mov_b32 v167, v165
    v_lshrrev_b32 v2, 1, v9
    v_lshlrev_b32 v2, 9, v2
    v_lshl_add_u32 v2, v3, 4, v2
    v_permlane16_swap_b32 v164, v166
    v_permlane16_swap_b32 v165, v167
    s_mov_b32 exec_lo, 0xffff
    s_mov_b32 exec_hi, 0xffff
    buffer_store_dwordx4 v[164:167], v2, s[20:23], s38 offen sc1
    s_mov_b64 exec, -1
    v_mov_b32 v77, v76
    s_nop 1
    v_permlane16_swap_b32 v76, v77
    s_nop 1
    v_add_f32 v76, v76, v77
    v_mov_b32 v77, v76
    s_nop 1
    v_permlane32_swap_b32 v76, v77
    s_nop 1
    v_add_f32 v76, v76, v77
    s_nop 1
    v_max_f32_dpp v76, v76, v76 quad_perm:[1,0,3,2] row_mask:0xf bank_mask:0xf
    s_nop 1
    v_max_f32_dpp v76, v76, v76 quad_perm:[2,3,0,1] row_mask:0xf bank_mask:0xf
    s_nop 1
    v_max_f32_dpp v76, v76, v76 row_half_mirror row_mask:0xf bank_mask:0xf
    s_nop 1
    v_max_f32_dpp v76, v76, v76 row_mirror row_mask:0xf bank_mask:0xf
    ds_write_b32 v5, v76
    s_branch sequential_preLN__grouped_kv_mqa__dense_activation_silu__prompt_kernel_A_fin
sequential_preLN__grouped_kv_mqa__dense_activation_silu__prompt_kernel_A_khi:
    s_lshl_b32 s39, s39, 7
    s_add_u32 s38, s38, s39
    v_lshlrev_b32 v2, 3, v3
    s_nop 1
    v_max_f32_dpp v76, v76, v76 quad_perm:[1,0,3,2] row_mask:0xf bank_mask:0xf
    s_nop 1
    v_max_f32_dpp v76, v76, v76 quad_perm:[2,3,0,1] row_mask:0xf bank_mask:0xf
    s_nop 1
    v_max_f32_dpp v76, v76, v76 row_half_mirror row_mask:0xf bank_mask:0xf
    s_nop 1
    v_max_f32_dpp v76, v76, v76 row_mirror row_mask:0xf bank_mask:0xf
    s_mov_b32 exec_lo, 0
    s_mov_b32 exec_hi, 0xffff0000
    buffer_store_dwordx2 v[164:165], v2, s[20:23], s38 offen offset:1024 sc1
    ds_write_b32 v5, v76
    s_branch sequential_preLN__grouped_kv_mqa__dense_activation_silu__prompt_kernel_A_fin
sequential_preLN__grouped_kv_mqa__dense_activation_silu__prompt_kernel_A_v:
    s_mul_i32 s39, s39, 640
    s_add_u32 s38, s38, s39
    s_and_b32 s39, s25, 1
    s_lshl_b32 s39, s39, 6
    s_add_u32 s38, s38, s39
    s_lshl_b32 s40, s3, 9
    s_add_u32 s40, s40, 143872
    v_bfe_u32 v2, v3, 2, 1
    v_lshlrev_b32 v2, 8, v2
    v_lshl_add_u32 v2, v9, 6, v2
    v_lshrrev_b32 v4, 3, v3
    v_lshl_add_u32 v2, v4, 3, v2
    v_and_b32 v4, 3, v3
    v_lshl_add_u32 v2, v4, 1, v2
    v_add_u32 v2, s40, v2
    ds_write_b16 v2, v164
    ds_write_b16_d16_hi v2, v164 offset:16
    ds_write_b16 v2, v165 offset:32
    ds_write_b16_d16_hi v2, v165 offset:48
    v_and_b32 v2, 31, v1
    v_lshl_add_u32 v2, v2, 4, s40
    v_mul_u32_u24 v4, 320, v9
    v_lshl_add_u32 v4, v3, 4, v4
    s_waitcnt lgkmcnt(0)
    ds_read_b128 v[164:167], v2
    s_bitcmp1_b32 s25, 0
    s_cselect_b32 exec_lo, 0xf000f000, -1
    s_mov_b32 exec_hi, 0
    s_waitcnt lgkmcnt(0)
    buffer_store_dwordx4 v[164:167], v4, s[20:23], s38 offen offset:1280 sc1
sequential_preLN__grouped_kv_mqa__dense_activation_silu__prompt_kernel_A_fin:
    s_mov_b64 exec, -1
    s_waitcnt lgkmcnt(0)
    s_barrier
    ds_read_b128 v[60:63], v6
    ds_read_b64_tr_b16 v[40:41], v11 offset:0
    ds_read_b64_tr_b16 v[42:43], v11 offset:2560
    ds_read_b64_tr_b16 v[44:45], v12 offset:0
    ds_read_b64_tr_b16 v[46:47], v12 offset:2560
    ds_read_b64_tr_b16 v[48:49], v13 offset:0
    ds_read_b64_tr_b16 v[50:51], v13 offset:2560
    ds_read_b64_tr_b16 v[52:53], v14 offset:0
    ds_read_b64_tr_b16 v[54:55], v14 offset:2560
    ds_read_b64_tr_b16 v[56:57], v15 offset:0
    ds_read_b64_tr_b16 v[58:59], v15 offset:2560
    ds_read_b128 v[84:87], v7
    ds_read_b64_tr_b16 v[64:65], v11 offset:5120
    ds_read_b64_tr_b16 v[66:67], v11 offset:7680
    ds_read_b64_tr_b16 v[68:69], v12 offset:5120
    ds_read_b64_tr_b16 v[70:71], v12 offset:7680
    ds_read_b64_tr_b16 v[72:73], v13 offset:5120
    ds_read_b64_tr_b16 v[74:75], v13 offset:7680
    ds_read_b64_tr_b16 v[76:77], v14 offset:5120
    ds_read_b64_tr_b16 v[78:79], v14 offset:7680
    ds_read_b64_tr_b16 v[80:81], v15 offset:5120
    ds_read_b64_tr_b16 v[82:83], v15 offset:7680
    s_add_u32 s40, s29, 10240
    s_cmp_eq_u32 s40, 40960
    s_cselect_b32 s40, 0, s40
    s_sub_u32 s32, s40, s29
    s_mov_b32 s29, s40
    v_add_u32 v6, 8192, v6
    v_add_u32 v7, 8192, v7
    v_add_u32 v11, s32, v11
    v_add_u32 v12, s32, v12
    v_add_u32 v13, s32, v13
    v_add_u32 v14, s32, v14
    v_add_u32 v15, s32, v15
    s_branch sequential_preLN__grouped_kv_mqa__dense_activation_silu__prompt_kernel_A_loop
.p2alignl 6, 0xBF800000
sequential_preLN__grouped_kv_mqa__dense_activation_silu__prompt_kernel_A_loop:
    s_cmp_lg_u32 s30, 0
    s_cbranch_scc1 sequential_preLN__grouped_kv_mqa__dense_activation_silu__prompt_kernel_A_nw
    s_waitcnt vmcnt(0)
sequential_preLN__grouped_kv_mqa__dense_activation_silu__prompt_kernel_A_nw:
    s_waitcnt lgkmcnt(0)
    s_barrier
    ds_read_b128 v[108:111], v6
    ds_read_b64_tr_b16 v[88:89], v11 offset:0
    ds_read_b64_tr_b16 v[90:91], v11 offset:2560
    v_mfma_f32_16x16x32_bf16 v[136:139], v[40:43], v[60:63], v[136:139]
    ds_read_b64_tr_b16 v[92:93], v12 offset:0
    ds_read_b64_tr_b16 v[94:95], v12 offset:2560
    v_mfma_f32_16x16x32_bf16 v[140:143], v[44:47], v[60:63], v[140:143]
    ds_read_b64_tr_b16 v[96:97], v13 offset:0
    ds_read_b64_tr_b16 v[98:99], v13 offset:2560
    ds_read_b64_tr_b16 v[100:101], v14 offset:0
    v_mfma_f32_16x16x32_bf16 v[144:147], v[48:51], v[60:63], v[144:147]
    ds_read_b64_tr_b16 v[102:103], v14 offset:2560
    ds_read_b64_tr_b16 v[104:105], v15 offset:0
    v_mfma_f32_16x16x32_bf16 v[148:151], v[52:55], v[60:63], v[148:151]
    ds_read_b64_tr_b16 v[106:107], v15 offset:2560
    ds_read_b128 v[132:135], v7
    ds_read_b64_tr_b16 v[112:113], v11 offset:5120
    v_mfma_f32_16x16x32_bf16 v[152:155], v[56:59], v[60:63], v[152:155]
    ds_read_b64_tr_b16 v[114:115], v11 offset:7680
    ds_read_b64_tr_b16 v[116:117], v12 offset:5120
    v_mfma_f32_16x16x32_bf16 v[28:31], v[40:43], v[16:19], v[28:31]
    ds_read_b64_tr_b16 v[118:119], v12 offset:7680
    ds_read_b64_tr_b16 v[120:121], v13 offset:5120
    ds_read_b64_tr_b16 v[122:123], v13 offset:7680
    v_mfma_f32_16x16x32_bf16 v[32:35], v[44:47], v[16:19], v[32:35]
    ds_read_b64_tr_b16 v[124:125], v14 offset:5120
    ds_read_b64_tr_b16 v[126:127], v14 offset:7680
    v_mfma_f32_16x16x32_bf16 v[136:139], v[64:67], v[84:87], v[136:139]
    ds_read_b64_tr_b16 v[128:129], v15 offset:5120
    ds_read_b64_tr_b16 v[130:131], v15 offset:7680
    v_mfma_f32_16x16x32_bf16 v[140:143], v[68:71], v[84:87], v[140:143]
    v_mfma_f32_16x16x32_bf16 v[144:147], v[72:75], v[84:87], v[144:147]
    s_add_u32 s40, s29, 10240
    s_cmp_eq_u32 s40, 40960
    s_cselect_b32 s40, 0, s40
    s_sub_u32 s32, s40, s29
    v_mfma_f32_16x16x32_bf16 v[148:151], v[76:79], v[84:87], v[148:151]
    s_mov_b32 s29, s40
    v_add_u32 v6, 8192, v6
    v_add_u32 v7, 8192, v7
    v_add_u32 v11, s32, v11
    v_mfma_f32_16x16x32_bf16 v[152:155], v[80:83], v[84:87], v[152:155]
    v_add_u32 v12, s32, v12
    v_add_u32 v13, s32, v13
    v_add_u32 v14, s32, v14
    v_add_u32 v15, s32, v15
    v_mfma_f32_16x16x32_bf16 v[28:31], v[64:67], v[16:19], v[28:31]
    s_add_u32 s30, s30, 1
    s_cmp_lt_u32 s30, 10
    v_mfma_f32_16x16x32_bf16 v[32:35], v[68:71], v[16:19], v[32:35]
    s_waitcnt lgkmcnt(0)
    s_barrier
    ds_read_b128 v[60:63], v6
    ds_read_b64_tr_b16 v[40:41], v11 offset:0
    ds_read_b64_tr_b16 v[42:43], v11 offset:2560
    v_mfma_f32_16x16x32_bf16 v[136:139], v[88:91], v[108:111], v[136:139]
    ds_read_b64_tr_b16 v[44:45], v12 offset:0
    ds_read_b64_tr_b16 v[46:47], v12 offset:2560
    v_mfma_f32_16x16x32_bf16 v[140:143], v[92:95], v[108:111], v[140:143]
    ds_read_b64_tr_b16 v[48:49], v13 offset:0
    ds_read_b64_tr_b16 v[50:51], v13 offset:2560
    ds_read_b64_tr_b16 v[52:53], v14 offset:0
    v_mfma_f32_16x16x32_bf16 v[144:147], v[96:99], v[108:111], v[144:147]
    ds_read_b64_tr_b16 v[54:55], v14 offset:2560
    ds_read_b64_tr_b16 v[56:57], v15 offset:0
    v_mfma_f32_16x16x32_bf16 v[148:151], v[100:103], v[108:111], v[148:151]
    ds_read_b64_tr_b16 v[58:59], v15 offset:2560
    ds_read_b128 v[84:87], v7
    ds_read_b64_tr_b16 v[64:65], v11 offset:5120
    v_mfma_f32_16x16x32_bf16 v[152:155], v[104:107], v[108:111], v[152:155]
    ds_read_b64_tr_b16 v[66:67], v11 offset:7680
    ds_read_b64_tr_b16 v[68:69], v12 offset:5120
    v_mfma_f32_16x16x32_bf16 v[28:31], v[88:91], v[16:19], v[28:31]
    ds_read_b64_tr_b16 v[70:71], v12 offset:7680
    ds_read_b64_tr_b16 v[72:73], v13 offset:5120
    ds_read_b64_tr_b16 v[74:75], v13 offset:7680
    v_mfma_f32_16x16x32_bf16 v[32:35], v[92:95], v[16:19], v[32:35]
    ds_read_b64_tr_b16 v[76:77], v14 offset:5120
    ds_read_b64_tr_b16 v[78:79], v14 offset:7680
    v_mfma_f32_16x16x32_bf16 v[136:139], v[112:115], v[132:135], v[136:139]
    ds_read_b64_tr_b16 v[80:81], v15 offset:5120
    ds_read_b64_tr_b16 v[82:83], v15 offset:7680
    v_mfma_f32_16x16x32_bf16 v[140:143], v[116:119], v[132:135], v[140:143]
    v_mfma_f32_16x16x32_bf16 v[144:147], v[120:123], v[132:135], v[144:147]
    s_add_u32 s40, s29, 10240
    s_cmp_eq_u32 s40, 40960
    s_cselect_b32 s40, 0, s40
    s_sub_u32 s32, s40, s29
    v_mfma_f32_16x16x32_bf16 v[148:151], v[124:127], v[132:135], v[148:151]
    s_mov_b32 s29, s40
    v_add_u32 v6, 8192, v6
    v_add_u32 v7, 8192, v7
    v_add_u32 v11, s32, v11
    v_mfma_f32_16x16x32_bf16 v[152:155], v[128:131], v[132:135], v[152:155]
    v_add_u32 v12, s32, v12
    v_add_u32 v13, s32, v13
    v_add_u32 v14, s32, v14
    v_add_u32 v15, s32, v15
    v_mfma_f32_16x16x32_bf16 v[28:31], v[112:115], v[16:19], v[28:31]
    s_add_u32 s30, s30, 1
    s_cmp_lt_u32 s30, 10
    v_mfma_f32_16x16x32_bf16 v[32:35], v[116:119], v[16:19], v[32:35]
    s_cbranch_scc1 sequential_preLN__grouped_kv_mqa__dense_activation_silu__prompt_kernel_A_loop
    s_waitcnt lgkmcnt(0)
    s_nop 4
    v_lshlrev_b32 v2, 4, v9
    s_lshl_b32 s38, s70, 6
    s_add_u32 s38, s38, 143360
    v_add_u32 v4, s38, v2
    ds_write_b128 v4, v[28:31]
    s_lshl_b32 s38, s71, 6
    s_add_u32 s38, s38, 143360
    v_add_u32 v4, s38, v2
    ds_write_b128 v4, v[32:35]
    s_waitcnt lgkmcnt(0)
    s_barrier
    s_lshl_b32 s38, s70, 6
    s_add_u32 s38, s38, 143360
    v_add_u32 v4, s38, v2
    ds_read_b128 v[40:43], v4
    s_lshl_b32 s38, s71, 6
    s_add_u32 s38, s38, 143360
    v_add_u32 v4, s38, v2
    ds_read_b128 v[44:47], v4
    s_lshl_b32 s38, s72, 6
    s_add_u32 s38, s38, 143360
    v_add_u32 v4, s38, v2
    ds_read_b128 v[48:51], v4
    s_lshl_b32 s38, s73, 6
    s_add_u32 s38, s38, 143360
    v_add_u32 v4, s38, v2
    ds_read_b128 v[52:55], v4
    s_lshl_b32 s38, s74, 6
    s_add_u32 s38, s38, 143360
    v_add_u32 v4, s38, v2
    ds_read_b128 v[56:59], v4
    v_mov_b32 v4, 143808
    ds_read_b32 v5, v4
    s_waitcnt lgkmcnt(5)
    v_fma_f32 v136, -v160, v40, v136
    v_fma_f32 v137, -v160, v41, v137
    v_fma_f32 v138, -v160, v42, v138
    v_fma_f32 v139, -v160, v43, v139
    v_mul_f32 v136, v162, v136
    v_mul_f32 v137, v162, v137
    v_mul_f32 v138, v162, v138
    v_mul_f32 v139, v162, v139
    s_lshl_b32 s38, s70, 5
    v_cvt_pk_bf16_f32 v80, v136, v137
    v_cvt_pk_bf16_f32 v81, v138, v139
    v_add_u32 v4, s38, v8
    ds_write_b64 v4, v[80:81]
    s_waitcnt lgkmcnt(5)
    v_fma_f32 v140, -v160, v44, v140
    v_fma_f32 v141, -v160, v45, v141
    v_fma_f32 v142, -v160, v46, v142
    v_fma_f32 v143, -v160, v47, v143
    v_mul_f32 v140, v162, v140
    v_mul_f32 v141, v162, v141
    v_mul_f32 v142, v162, v142
    v_mul_f32 v143, v162, v143
    s_lshl_b32 s38, s71, 5
    v_cvt_pk_bf16_f32 v82, v140, v141
    v_cvt_pk_bf16_f32 v83, v142, v143
    v_add_u32 v4, s38, v8
    ds_write_b64 v4, v[82:83]
    s_waitcnt lgkmcnt(5)
    v_fma_f32 v144, -v160, v48, v144
    v_fma_f32 v145, -v160, v49, v145
    v_fma_f32 v146, -v160, v50, v146
    v_fma_f32 v147, -v160, v51, v147
    v_mul_f32 v144, v162, v144
    v_mul_f32 v145, v162, v145
    v_mul_f32 v146, v162, v146
    v_mul_f32 v147, v162, v147
    s_lshl_b32 s38, s72, 5
    v_cvt_pk_bf16_f32 v84, v144, v145
    v_cvt_pk_bf16_f32 v85, v146, v147
    v_add_u32 v4, s38, v8
    ds_write_b64 v4, v[84:85]
    s_waitcnt lgkmcnt(5)
    v_fma_f32 v148, -v160, v52, v148
    v_fma_f32 v149, -v160, v53, v149
    v_fma_f32 v150, -v160, v54, v150
    v_fma_f32 v151, -v160, v55, v151
    v_mul_f32 v148, v162, v148
    v_mul_f32 v149, v162, v149
    v_mul_f32 v150, v162, v150
    v_mul_f32 v151, v162, v151
    s_lshl_b32 s38, s73, 5
    v_cvt_pk_bf16_f32 v86, v148, v149
    v_cvt_pk_bf16_f32 v87, v150, v151
    v_add_u32 v4, s38, v8
    ds_write_b64 v4, v[86:87]
    s_waitcnt lgkmcnt(5)
    v_fma_f32 v152, -v160, v56, v152
    v_fma_f32 v153, -v160, v57, v153
    v_fma_f32 v154, -v160, v58, v154
    v_fma_f32 v155, -v160, v59, v155
    v_mul_f32 v152, v162, v152
    v_mul_f32 v153, v162, v153
    v_mul_f32 v154, v162, v154
    v_mul_f32 v155, v162, v155
    s_lshl_b32 s38, s74, 5
    v_cvt_pk_bf16_f32 v88, v152, v153
    v_cvt_pk_bf16_f32 v89, v154, v155
    v_add_u32 v4, s38, v8
    ds_write_b64 v4, v[88:89]
    s_waitcnt lgkmcnt(0)
    v_readfirstlane_b32 s100, v5
    s_barrier
sequential_preLN__grouped_kv_mqa__dense_activation_silu__prompt_kernel_M:
    v_and_b32 v1, 63, v0
    v_lshrrev_b32 v2, 6, v0
    s_and_b32 s60, s2, 7
    v_readfirstlane_b32 s3, v2
    v_lshlrev_b32 v6, 4, v1
    s_lshr_b32 s61, s2, 3
    s_and_b32 s62, s3, 3
    s_cmp_lt_u32 s3, 8
    s_cbranch_scc1 sequential_preLN__grouped_kv_mqa__dense_activation_silu__prompt_kernel_att
    s_setprio 3
    s_mov_b32 s24, 2621440
    s_mov_b32 m0, 0
    s_mov_b32 s4, s76
    s_mov_b32 s5, s77
    s_mov_b32 s6, 25165824
    s_mov_b32 s7, 0x00020000
    s_lshl_b32 s15, s60, 14
    s_add_u32 s15, s15, 23592960
    s_mov_b32 s39, 524288
    v_lshlrev_b32 v24, 7, v1
    v_lshlrev_b32 v25, 7, v1
    v_add_u32 v25, 8192, v25
    buffer_load_dwordx2 v[20:21], v24, s[4:7], s15 offen sc1
    buffer_load_dwordx2 v[22:23], v25, s[4:7], s15 offen sc1
sequential_preLN__grouped_kv_mqa__dense_activation_silu__prompt_kernel_polek:
    s_barrier
    s_barrier
    s_barrier
    s_barrier
    s_barrier
    s_branch sequential_preLN__grouped_kv_mqa__dense_activation_silu__prompt_kernel_pollwk
sequential_preLN__grouped_kv_mqa__dense_activation_silu__prompt_kernel_pollk:
    buffer_load_dwordx2 v[20:21], v24, s[4:7], s15 offen sc1
    buffer_load_dwordx2 v[22:23], v25, s[4:7], s15 offen sc1
sequential_preLN__grouped_kv_mqa__dense_activation_silu__prompt_kernel_pollwk:
    s_waitcnt vmcnt(0)
    v_xor_b32 v26, s100, v21
    v_xor_b32 v27, s100, v23
    v_or_b32 v26, v26, v27
    v_cmp_ne_u32 vcc, 0, v26
    s_sub_u32 s39, s39, 1
    s_cbranch_scc1 sequential_preLN__grouped_kv_mqa__dense_activation_silu__prompt_kernel_pollxk
    s_nop 1
    s_cmp_eq_u64 vcc, 0
    s_cbranch_scc1 sequential_preLN__grouped_kv_mqa__dense_activation_silu__prompt_kernel_pollxk
    s_sleep 2
    s_branch sequential_preLN__grouped_kv_mqa__dense_activation_silu__prompt_kernel_pollk
sequential_preLN__grouped_kv_mqa__dense_activation_silu__prompt_kernel_pollxk:
    s_mov_b64 exec, -1
    v_add_f32_dpp v20, v20, v20 quad_perm:[1,0,3,2] row_mask:0xf bank_mask:0xf
    v_add_f32_dpp v22, v22, v22 quad_perm:[1,0,3,2] row_mask:0xf bank_mask:0xf
    s_nop 0
    v_max_f32 v20, v20, v22
    s_nop 1
    v_max_f32_dpp v20, v20, v20 quad_perm:[1,0,3,2] row_mask:0xf bank_mask:0xf
    s_nop 1
    v_max_f32_dpp v20, v20, v20 quad_perm:[2,3,0,1] row_mask:0xf bank_mask:0xf
    s_nop 1
    v_max_f32_dpp v20, v20, v20 row_half_mirror row_mask:0xf bank_mask:0xf
    s_nop 1
    v_max_f32_dpp v20, v20, v20 row_mirror row_mask:0xf bank_mask:0xf
    v_mov_b32 v21, v20
    s_nop 1
    v_permlane16_swap_b32 v20, v21
    s_nop 1
    v_max_f32 v20, v20, v21
    v_mov_b32 v21, v20
    s_nop 1
    v_permlane32_swap_b32 v20, v21
    s_nop 1
    v_max_f32 v20, v20, v21
    v_mov_b32 v21, 163776
    ds_write_b32 v21, v20
    s_waitcnt lgkmcnt(0)
    s_mov_b32 s18, 4
sequential_preLN__grouped_kv_mqa__dense_activation_silu__prompt_kernel_dmaa0:
    buffer_load_dwordx4 v6, s[4:7], s24 offen offset:0 sc1 lds
    buffer_load_dwordx4 v6, s[4:7], s24 offen offset:1024 sc1 lds
    buffer_load_dwordx4 v6, s[4:7], s24 offen offset:2048 sc1 lds
    buffer_load_dwordx4 v6, s[4:7], s24 offen offset:3072 sc1 lds
    s_add_u32 s24, s24, 4096
    s_add_u32 m0, m0, 4096
    s_waitcnt vmcnt(44)
    s_sub_u32 s18, s18, 1
    s_cmp_lg_u32 s18, 0
    s_cbranch_scc1 sequential_preLN__grouped_kv_mqa__dense_activation_silu__prompt_kernel_dmaa0
    s_barrier
    s_mov_b32 s18, 4
sequential_preLN__grouped_kv_mqa__dense_activation_silu__prompt_kernel_dmaa:
    buffer_load_dwordx4 v6, s[4:7], s24 offen offset:0 sc1 lds
    buffer_load_dwordx4 v6, s[4:7], s24 offen offset:1024 sc1 lds
    buffer_load_dwordx4 v6, s[4:7], s24 offen offset:2048 sc1 lds
    buffer_load_dwordx4 v6, s[4:7], s24 offen offset:3072 sc1 lds
    s_add_u32 s24, s24, 4096
    s_add_u32 m0, m0, 4096
    s_waitcnt vmcnt(44)
    s_sub_u32 s18, s18, 1
    s_cmp_lg_u32 s18, 0
    s_cbranch_scc1 sequential_preLN__grouped_kv_mqa__dense_activation_silu__prompt_kernel_dmaa
    s_waitcnt vmcnt(16)
    s_barrier
    s_mov_b32 s18, 16
sequential_preLN__grouped_kv_mqa__dense_activation_silu__prompt_kernel_dmab:
    buffer_load_dwordx4 v6, s[4:7], s24 offen offset:0 sc1 lds
    buffer_load_dwordx4 v6, s[4:7], s24 offen offset:1024 sc1 lds
    buffer_load_dwordx4 v6, s[4:7], s24 offen offset:2048 sc1 lds
    buffer_load_dwordx4 v6, s[4:7], s24 offen offset:3072 sc1 lds
    s_add_u32 s24, s24, 4096
    s_add_u32 m0, m0, 4096
    s_waitcnt vmcnt(44)
    s_sub_u32 s18, s18, 1
    s_cmp_lg_u32 s18, 0
    s_cbranch_scc1 sequential_preLN__grouped_kv_mqa__dense_activation_silu__prompt_kernel_dmab
    s_waitcnt vmcnt(32)
    s_barrier
    s_mov_b32 s18, 16
sequential_preLN__grouped_kv_mqa__dense_activation_silu__prompt_kernel_dmac:
    buffer_load_dwordx4 v6, s[4:7], s24 offen offset:0 sc1 lds
    buffer_load_dwordx4 v6, s[4:7], s24 offen offset:1024 sc1 lds
    buffer_load_dwordx4 v6, s[4:7], s24 offen offset:2048 sc1 lds
    buffer_load_dwordx4 v6, s[4:7], s24 offen offset:3072 sc1 lds
    s_add_u32 s24, s24, 4096
    s_add_u32 m0, m0, 4096
    s_waitcnt vmcnt(44)
    s_sub_u32 s18, s18, 1
    s_cmp_lg_u32 s18, 0
    s_cbranch_scc1 sequential_preLN__grouped_kv_mqa__dense_activation_silu__prompt_kernel_dmac
    s_waitcnt vmcnt(0)
    v_lshrrev_b32 v3, 4, v1
    v_and_b32 v4, 15, v1
    v_mov_b32 v12, 0x3f803f80
    v_mov_b32 v13, v12
    v_mov_b32 v14, v12
    v_mov_b32 v15, v12
    v_lshlrev_b32 v11, 4, v3
    s_mul_i32 s41, s2, 5
    s_add_u32 s41, s41, 0
    s_mov_b32 s28, s82
    s_mov_b32 s29, s83
    s_mov_b32 s30, 819200
    s_mov_b32 s31, 0x00020000
    s_mov_b32 s32, 1280
    s_mov_b32 s65, 5
    s_mov_b32 s66, 13108
    s_mov_b32 s67, 102400
    s_mov_b32 s63, 15728640
    s_mov_b32 s15, s41
    s_cmp_lt_u32 s41, 200
    s_cbranch_scc1 sequential_preLN__grouped_kv_mqa__dense_activation_silu__prompt_kernel_j0_rp10
    s_cmp_lt_u32 s41, 740
    s_cbranch_scc1 sequential_preLN__grouped_kv_mqa__dense_activation_silu__prompt_kernel_j0_rpw1
    s_mov_b32 s28, s86
    s_mov_b32 s29, s87
    s_mov_b32 s30, 2211840
    s_mov_b32 s67, 276480
    s_mov_b32 s63, 19398656
    s_sub_u32 s15, s41, 740
sequential_preLN__grouped_kv_mqa__dense_activation_silu__prompt_kernel_j0_rp10:
    s_mul_i32 s33, s15, 6554
    s_lshr_b32 s33, s33, 16
    s_mul_i32 s16, s33, 10
    s_sub_u32 s64, s15, s16
    s_branch sequential_preLN__grouped_kv_mqa__dense_activation_silu__prompt_kernel_j0_rpgo
sequential_preLN__grouped_kv_mqa__dense_activation_silu__prompt_kernel_j0_rpw1:
    s_mov_b32 s28, s84
    s_mov_b32 s29, s85
    s_mov_b32 s30, 2211840
    s_mov_b32 s32, 3456
    s_mov_b32 s65, 7
    s_mov_b32 s66, 9363
    s_mov_b32 s67, 143360
    s_mov_b32 s63, 16777216
    s_sub_u32 s15, s41, 200
    s_mul_i32 s33, s15, 2428
    s_lshr_b32 s33, s33, 16
    s_mul_i32 s16, s33, 27
    s_sub_u32 s64, s15, s16
sequential_preLN__grouped_kv_mqa__dense_activation_silu__prompt_kernel_j0_rpgo:
    s_lshl_b32 s15, s32, 3
    v_mul_lo_u32 v2, v3, s15
    v_lshl_add_u32 v2, v4, 1, v2
    s_mul_i32 s15, s33, s32
    s_lshl_b32 s15, s15, 5
    s_lshl_b32 s16, s64, 7
    s_add_u32 s15, s15, s16
    buffer_load_ushort v32, v2, s[28:31], s15 offen offset:0
    buffer_load_ushort v40, v2, s[28:31], s15 offen offset:32
    buffer_load_ushort v48, v2, s[28:31], s15 offen offset:64
    buffer_load_ushort v56, v2, s[28:31], s15 offen offset:96
    s_add_u32 s15, s15, s32
    buffer_load_ushort v33, v2, s[28:31], s15 offen offset:0
    buffer_load_ushort v41, v2, s[28:31], s15 offen offset:32
    buffer_load_ushort v49, v2, s[28:31], s15 offen offset:64
    buffer_load_ushort v57, v2, s[28:31], s15 offen offset:96
    s_add_u32 s15, s15, s32
    buffer_load_ushort v34, v2, s[28:31], s15 offen offset:0
    buffer_load_ushort v42, v2, s[28:31], s15 offen offset:32
    buffer_load_ushort v50, v2, s[28:31], s15 offen offset:64
    buffer_load_ushort v58, v2, s[28:31], s15 offen offset:96
    s_add_u32 s15, s15, s32
    buffer_load_ushort v35, v2, s[28:31], s15 offen offset:0
    buffer_load_ushort v43, v2, s[28:31], s15 offen offset:32
    buffer_load_ushort v51, v2, s[28:31], s15 offen offset:64
    buffer_load_ushort v59, v2, s[28:31], s15 offen offset:96
    s_add_u32 s15, s15, s32
    buffer_load_ushort v36, v2, s[28:31], s15 offen offset:0
    buffer_load_ushort v44, v2, s[28:31], s15 offen offset:32
    buffer_load_ushort v52, v2, s[28:31], s15 offen offset:64
    buffer_load_ushort v60, v2, s[28:31], s15 offen offset:96
    s_add_u32 s15, s15, s32
    buffer_load_ushort v37, v2, s[28:31], s15 offen offset:0
    buffer_load_ushort v45, v2, s[28:31], s15 offen offset:32
    buffer_load_ushort v53, v2, s[28:31], s15 offen offset:64
    buffer_load_ushort v61, v2, s[28:31], s15 offen offset:96
    s_add_u32 s15, s15, s32
    buffer_load_ushort v38, v2, s[28:31], s15 offen offset:0
    buffer_load_ushort v46, v2, s[28:31], s15 offen offset:32
    buffer_load_ushort v54, v2, s[28:31], s15 offen offset:64
    buffer_load_ushort v62, v2, s[28:31], s15 offen offset:96
    s_add_u32 s15, s15, s32
    buffer_load_ushort v39, v2, s[28:31], s15 offen offset:0
    buffer_load_ushort v47, v2, s[28:31], s15 offen offset:32
    buffer_load_ushort v55, v2, s[28:31], s15 offen offset:64
    buffer_load_ushort v63, v2, s[28:31], s15 offen offset:96
    s_mul_i32 s17, s33, s65
    s_lshl_b32 s17, s17, 10
    s_add_u32 s63, s63, s17
    s_cmp_eq_u32 s65, 7
    s_cselect_b32 s17, s33, 20
    s_mul_i32 s17, s17, 7168
    s_lshl_b32 s16, s64, 8
    s_add_u32 s17, s17, s16
    s_add_u32 s44, s17, 1048576
    s_lshl_b32 s64, s64, 2
    s_barrier
    s_mul_i32 s41, s2, 5
    s_add_u32 s41, s41, 1
    s_mov_b32 s28, s82
    s_mov_b32 s29, s83
    s_mov_b32 s30, 819200
    s_mov_b32 s31, 0x00020000
    s_mov_b32 s32, 1280
    s_mov_b32 s70, 5
    s_mov_b32 s71, 13108
    s_mov_b32 s43, 102400
    s_mov_b32 s68, 15728640
    s_mov_b32 s15, s41
    s_cmp_lt_u32 s41, 200
    s_cbranch_scc1 sequential_preLN__grouped_kv_mqa__dense_activation_silu__prompt_kernel_j1_rp10
    s_cmp_lt_u32 s41, 740
    s_cbranch_scc1 sequential_preLN__grouped_kv_mqa__dense_activation_silu__prompt_kernel_j1_rpw1
    s_mov_b32 s28, s86
    s_mov_b32 s29, s87
    s_mov_b32 s30, 2211840
    s_mov_b32 s43, 276480
    s_mov_b32 s68, 19398656
    s_sub_u32 s15, s41, 740
sequential_preLN__grouped_kv_mqa__dense_activation_silu__prompt_kernel_j1_rp10:
    s_mul_i32 s33, s15, 6554
    s_lshr_b32 s33, s33, 16
    s_mul_i32 s16, s33, 10
    s_sub_u32 s69, s15, s16
    s_branch sequential_preLN__grouped_kv_mqa__dense_activation_silu__prompt_kernel_j1_rpgo
sequential_preLN__grouped_kv_mqa__dense_activation_silu__prompt_kernel_j1_rpw1:
    s_mov_b32 s28, s84
    s_mov_b32 s29, s85
    s_mov_b32 s30, 2211840
    s_mov_b32 s32, 3456
    s_mov_b32 s70, 7
    s_mov_b32 s71, 9363
    s_mov_b32 s43, 143360
    s_mov_b32 s68, 16777216
    s_sub_u32 s15, s41, 200
    s_mul_i32 s33, s15, 2428
    s_lshr_b32 s33, s33, 16
    s_mul_i32 s16, s33, 27
    s_sub_u32 s69, s15, s16
sequential_preLN__grouped_kv_mqa__dense_activation_silu__prompt_kernel_j1_rpgo:
    s_lshl_b32 s15, s32, 3
    v_mul_lo_u32 v2, v3, s15
    v_lshl_add_u32 v2, v4, 1, v2
    s_mul_i32 s15, s33, s32
    s_lshl_b32 s15, s15, 5
    s_lshl_b32 s16, s69, 7
    s_add_u32 s15, s15, s16
    buffer_load_ushort v64, v2, s[28:31], s15 offen offset:0
    buffer_load_ushort v72, v2, s[28:31], s15 offen offset:32
    buffer_load_ushort v80, v2, s[28:31], s15 offen offset:64
    buffer_load_ushort v88, v2, s[28:31], s15 offen offset:96
    s_add_u32 s15, s15, s32
    buffer_load_ushort v65, v2, s[28:31], s15 offen offset:0
    buffer_load_ushort v73, v2, s[28:31], s15 offen offset:32
    buffer_load_ushort v81, v2, s[28:31], s15 offen offset:64
    buffer_load_ushort v89, v2, s[28:31], s15 offen offset:96
    s_add_u32 s15, s15, s32
    buffer_load_ushort v66, v2, s[28:31], s15 offen offset:0
    buffer_load_ushort v74, v2, s[28:31], s15 offen offset:32
    buffer_load_ushort v82, v2, s[28:31], s15 offen offset:64
    buffer_load_ushort v90, v2, s[28:31], s15 offen offset:96
    s_add_u32 s15, s15, s32
    buffer_load_ushort v67, v2, s[28:31], s15 offen offset:0
    buffer_load_ushort v75, v2, s[28:31], s15 offen offset:32
    buffer_load_ushort v83, v2, s[28:31], s15 offen offset:64
    buffer_load_ushort v91, v2, s[28:31], s15 offen offset:96
    s_add_u32 s15, s15, s32
    buffer_load_ushort v68, v2, s[28:31], s15 offen offset:0
    buffer_load_ushort v76, v2, s[28:31], s15 offen offset:32
    buffer_load_ushort v84, v2, s[28:31], s15 offen offset:64
    buffer_load_ushort v92, v2, s[28:31], s15 offen offset:96
    s_add_u32 s15, s15, s32
    buffer_load_ushort v69, v2, s[28:31], s15 offen offset:0
    buffer_load_ushort v77, v2, s[28:31], s15 offen offset:32
    buffer_load_ushort v85, v2, s[28:31], s15 offen offset:64
    buffer_load_ushort v93, v2, s[28:31], s15 offen offset:96
    s_add_u32 s15, s15, s32
    buffer_load_ushort v70, v2, s[28:31], s15 offen offset:0
    buffer_load_ushort v78, v2, s[28:31], s15 offen offset:32
    buffer_load_ushort v86, v2, s[28:31], s15 offen offset:64
    buffer_load_ushort v94, v2, s[28:31], s15 offen offset:96
    s_add_u32 s15, s15, s32
    buffer_load_ushort v71, v2, s[28:31], s15 offen offset:0
    buffer_load_ushort v79, v2, s[28:31], s15 offen offset:32
    buffer_load_ushort v87, v2, s[28:31], s15 offen offset:64
    buffer_load_ushort v95, v2, s[28:31], s15 offen offset:96
    s_mul_i32 s17, s33, s70
    s_lshl_b32 s17, s17, 10
    s_add_u32 s68, s68, s17
    s_cmp_eq_u32 s70, 7
    s_cselect_b32 s17, s33, 20
    s_mul_i32 s17, s17, 7168
    s_lshl_b32 s16, s69, 8
    s_add_u32 s17, s17, s16
    s_add_u32 s45, s17, 1048576
    s_lshl_b32 s69, s69, 2
    s_waitcnt vmcnt(32)
    v_lshl_or_b32 v96, v33, 16, v32
    v_lshl_or_b32 v97, v35, 16, v34
    v_lshl_or_b32 v98, v37, 16, v36
    v_lshl_or_b32 v99, v39, 16, v38
    s_sub_i32 s15, s64, 84
    s_max_i32 s15, s15, 0
    s_mul_i32 s15, s15, 43
    s_lshr_b32 s15, s15, 8
    s_add_u32 s15, s15, s64
    s_mul_i32 s16, s15, s66
    s_lshr_b32 s16, s16, 16
    s_mul_i32 s17, s16, s65
    s_sub_u32 s15, s15, s17
    s_mul_i32 s16, s16, s67
    s_lshl_b32 s15, s15, 10
    s_add_u32 s15, s15, s16
    s_add_u32 s15, s15, s63
    v_mfma_f32_16x16x32_bf16 v[128:131], v[96:99], v[12:15], 0
    buffer_store_dwordx4 v[96:99], v6, s[4:7], s15 offen sc1
    s_add_u32 s64, s64, 1
    v_lshl_or_b32 v100, v41, 16, v40
    v_lshl_or_b32 v101, v43, 16, v42
    v_lshl_or_b32 v102, v45, 16, v44
    v_lshl_or_b32 v103, v47, 16, v46
    s_sub_i32 s15, s64, 84
    s_max_i32 s15, s15, 0
    s_mul_i32 s15, s15, 43
    s_lshr_b32 s15, s15, 8
    s_add_u32 s15, s15, s64
    s_mul_i32 s16, s15, s66
    s_lshr_b32 s16, s16, 16
    s_mul_i32 s17, s16, s65
    s_sub_u32 s15, s15, s17
    s_mul_i32 s16, s16, s67
    s_lshl_b32 s15, s15, 10
    s_add_u32 s15, s15, s16
    s_add_u32 s15, s15, s63
    v_mfma_f32_16x16x32_bf16 v[132:135], v[100:103], v[12:15], 0
    buffer_store_dwordx4 v[100:103], v6, s[4:7], s15 offen sc1
    s_add_u32 s64, s64, 1
    v_lshl_or_b32 v104, v49, 16, v48
    v_lshl_or_b32 v105, v51, 16, v50
    v_lshl_or_b32 v106, v53, 16, v52
    v_lshl_or_b32 v107, v55, 16, v54
    s_sub_i32 s15, s64, 84
    s_max_i32 s15, s15, 0
    s_mul_i32 s15, s15, 43
    s_lshr_b32 s15, s15, 8
    s_add_u32 s15, s15, s64
    s_mul_i32 s16, s15, s66
    s_lshr_b32 s16, s16, 16
    s_mul_i32 s17, s16, s65
    s_sub_u32 s15, s15, s17
    s_mul_i32 s16, s16, s67
    s_lshl_b32 s15, s15, 10
    s_add_u32 s15, s15, s16
    s_add_u32 s15, s15, s63
    v_mfma_f32_16x16x32_bf16 v[136:139], v[104:107], v[12:15], 0
    buffer_store_dwordx4 v[104:107], v6, s[4:7], s15 offen sc1
    s_add_u32 s64, s64, 1
    v_lshl_or_b32 v108, v57, 16, v56
    v_lshl_or_b32 v109, v59, 16, v58
    v_lshl_or_b32 v110, v61, 16, v60
    v_lshl_or_b32 v111, v63, 16, v62
    s_sub_i32 s15, s64, 84
    s_max_i32 s15, s15, 0
    s_mul_i32 s15, s15, 43
    s_lshr_b32 s15, s15, 8
    s_add_u32 s15, s15, s64
    s_mul_i32 s16, s15, s66
    s_lshr_b32 s16, s16, 16
    s_mul_i32 s17, s16, s65
    s_sub_u32 s15, s15, s17
    s_mul_i32 s16, s16, s67
    s_lshl_b32 s15, s15, 10
    s_add_u32 s15, s15, s16
    s_add_u32 s15, s15, s63
    v_mfma_f32_16x16x32_bf16 v[140:143], v[108:111], v[12:15], 0
    buffer_store_dwordx4 v[108:111], v6, s[4:7], s15 offen sc1
    s_add_u32 s64, s64, 1
    s_nop 7
    s_mov_b32 exec_lo, 0x00010001
    s_mov_b32 exec_hi, 0x00010001
    buffer_store_dwordx4 v[128:131], v11, s[4:7], s44 offen offset:0 sc1
    buffer_store_dwordx4 v[132:135], v11, s[4:7], s44 offen offset:64 sc1
    buffer_store_dwordx4 v[136:139], v11, s[4:7], s44 offen offset:128 sc1
    buffer_store_dwordx4 v[140:143], v11, s[4:7], s44 offen offset:192 sc1
    s_mov_b64 exec, -1
    s_mul_i32 s41, s2, 5
    s_add_u32 s41, s41, 2
    s_mov_b32 s28, s82
    s_mov_b32 s29, s83
    s_mov_b32 s30, 819200
    s_mov_b32 s31, 0x00020000
    s_mov_b32 s32, 1280
    s_mov_b32 s65, 5
    s_mov_b32 s66, 13108
    s_mov_b32 s67, 102400
    s_mov_b32 s63, 15728640
    s_mov_b32 s15, s41
    s_cmp_lt_u32 s41, 200
    s_cbranch_scc1 sequential_preLN__grouped_kv_mqa__dense_activation_silu__prompt_kernel_j2_rp10
    s_cmp_lt_u32 s41, 740
    s_cbranch_scc1 sequential_preLN__grouped_kv_mqa__dense_activation_silu__prompt_kernel_j2_rpw1
    s_mov_b32 s28, s86
    s_mov_b32 s29, s87
    s_mov_b32 s30, 2211840
    s_mov_b32 s67, 276480
    s_mov_b32 s63, 19398656
    s_sub_u32 s15, s41, 740
sequential_preLN__grouped_kv_mqa__dense_activation_silu__prompt_kernel_j2_rp10:
    s_mul_i32 s33, s15, 6554
    s_lshr_b32 s33, s33, 16
    s_mul_i32 s16, s33, 10
    s_sub_u32 s64, s15, s16
    s_branch sequential_preLN__grouped_kv_mqa__dense_activation_silu__prompt_kernel_j2_rpgo
sequential_preLN__grouped_kv_mqa__dense_activation_silu__prompt_kernel_j2_rpw1:
    s_mov_b32 s28, s84
    s_mov_b32 s29, s85
    s_mov_b32 s30, 2211840
    s_mov_b32 s32, 3456
    s_mov_b32 s65, 7
    s_mov_b32 s66, 9363
    s_mov_b32 s67, 143360
    s_mov_b32 s63, 16777216
    s_sub_u32 s15, s41, 200
    s_mul_i32 s33, s15, 2428
    s_lshr_b32 s33, s33, 16
    s_mul_i32 s16, s33, 27
    s_sub_u32 s64, s15, s16
sequential_preLN__grouped_kv_mqa__dense_activation_silu__prompt_kernel_j2_rpgo:
    s_lshl_b32 s15, s32, 3
    v_mul_lo_u32 v2, v3, s15
    v_lshl_add_u32 v2, v4, 1, v2
    s_mul_i32 s15, s33, s32
    s_lshl_b32 s15, s15, 5
    s_lshl_b32 s16, s64, 7
    s_add_u32 s15, s15, s16
    buffer_load_ushort v32, v2, s[28:31], s15 offen offset:0
    buffer_load_ushort v40, v2, s[28:31], s15 offen offset:32
    buffer_load_ushort v48, v2, s[28:31], s15 offen offset:64
    buffer_load_ushort v56, v2, s[28:31], s15 offen offset:96
    s_add_u32 s15, s15, s32
    buffer_load_ushort v33, v2, s[28:31], s15 offen offset:0
    buffer_load_ushort v41, v2, s[28:31], s15 offen offset:32
    buffer_load_ushort v49, v2, s[28:31], s15 offen offset:64
    buffer_load_ushort v57, v2, s[28:31], s15 offen offset:96
    s_add_u32 s15, s15, s32
    buffer_load_ushort v34, v2, s[28:31], s15 offen offset:0
    buffer_load_ushort v42, v2, s[28:31], s15 offen offset:32
    buffer_load_ushort v50, v2, s[28:31], s15 offen offset:64
    buffer_load_ushort v58, v2, s[28:31], s15 offen offset:96
    s_add_u32 s15, s15, s32
    buffer_load_ushort v35, v2, s[28:31], s15 offen offset:0
    buffer_load_ushort v43, v2, s[28:31], s15 offen offset:32
    buffer_load_ushort v51, v2, s[28:31], s15 offen offset:64
    buffer_load_ushort v59, v2, s[28:31], s15 offen offset:96
    s_add_u32 s15, s15, s32
    buffer_load_ushort v36, v2, s[28:31], s15 offen offset:0
    buffer_load_ushort v44, v2, s[28:31], s15 offen offset:32
    buffer_load_ushort v52, v2, s[28:31], s15 offen offset:64
    buffer_load_ushort v60, v2, s[28:31], s15 offen offset:96
    s_add_u32 s15, s15, s32
    buffer_load_ushort v37, v2, s[28:31], s15 offen offset:0
    buffer_load_ushort v45, v2, s[28:31], s15 offen offset:32
    buffer_load_ushort v53, v2, s[28:31], s15 offen offset:64
    buffer_load_ushort v61, v2, s[28:31], s15 offen offset:96
    s_add_u32 s15, s15, s32
    buffer_load_ushort v38, v2, s[28:31], s15 offen offset:0
    buffer_load_ushort v46, v2, s[28:31], s15 offen offset:32
    buffer_load_ushort v54, v2, s[28:31], s15 offen offset:64
    buffer_load_ushort v62, v2, s[28:31], s15 offen offset:96
    s_add_u32 s15, s15, s32
    buffer_load_ushort v39, v2, s[28:31], s15 offen offset:0
    buffer_load_ushort v47, v2, s[28:31], s15 offen offset:32
    buffer_load_ushort v55, v2, s[28:31], s15 offen offset:64
    buffer_load_ushort v63, v2, s[28:31], s15 offen offset:96
    s_mul_i32 s17, s33, s65
    s_lshl_b32 s17, s17, 10
    s_add_u32 s63, s63, s17
    s_cmp_eq_u32 s65, 7
    s_cselect_b32 s17, s33, 20
    s_mul_i32 s17, s17, 7168
    s_lshl_b32 s16, s64, 8
    s_add_u32 s17, s17, s16
    s_add_u32 s44, s17, 1048576
    s_lshl_b32 s64, s64, 2
    s_waitcnt vmcnt(32)
    v_lshl_or_b32 v112, v65, 16, v64
    v_lshl_or_b32 v113, v67, 16, v66
    v_lshl_or_b32 v114, v69, 16, v68
    v_lshl_or_b32 v115, v71, 16, v70
    s_sub_i32 s15, s69, 84
    s_max_i32 s15, s15, 0
    s_mul_i32 s15, s15, 43
    s_lshr_b32 s15, s15, 8
    s_add_u32 s15, s15, s69
    s_mul_i32 s16, s15, s71
    s_lshr_b32 s16, s16, 16
    s_mul_i32 s17, s16, s70
    s_sub_u32 s15, s15, s17
    s_mul_i32 s16, s16, s43
    s_lshl_b32 s15, s15, 10
    s_add_u32 s15, s15, s16
    s_add_u32 s15, s15, s68
    v_mfma_f32_16x16x32_bf16 v[128:131], v[112:115], v[12:15], 0
    buffer_store_dwordx4 v[112:115], v6, s[4:7], s15 offen sc1
    s_add_u32 s69, s69, 1
    v_lshl_or_b32 v116, v73, 16, v72
    v_lshl_or_b32 v117, v75, 16, v74
    v_lshl_or_b32 v118, v77, 16, v76
    v_lshl_or_b32 v119, v79, 16, v78
    s_sub_i32 s15, s69, 84
    s_max_i32 s15, s15, 0
    s_mul_i32 s15, s15, 43
    s_lshr_b32 s15, s15, 8
    s_add_u32 s15, s15, s69
    s_mul_i32 s16, s15, s71
    s_lshr_b32 s16, s16, 16
    s_mul_i32 s17, s16, s70
    s_sub_u32 s15, s15, s17
    s_mul_i32 s16, s16, s43
    s_lshl_b32 s15, s15, 10
    s_add_u32 s15, s15, s16
    s_add_u32 s15, s15, s68
    v_mfma_f32_16x16x32_bf16 v[132:135], v[116:119], v[12:15], 0
    buffer_store_dwordx4 v[116:119], v6, s[4:7], s15 offen sc1
    s_add_u32 s69, s69, 1
    v_lshl_or_b32 v120, v81, 16, v80
    v_lshl_or_b32 v121, v83, 16, v82
    v_lshl_or_b32 v122, v85, 16, v84
    v_lshl_or_b32 v123, v87, 16, v86
    s_sub_i32 s15, s69, 84
    s_max_i32 s15, s15, 0
    s_mul_i32 s15, s15, 43
    s_lshr_b32 s15, s15, 8
    s_add_u32 s15, s15, s69
    s_mul_i32 s16, s15, s71
    s_lshr_b32 s16, s16, 16
    s_mul_i32 s17, s16, s70
    s_sub_u32 s15, s15, s17
    s_mul_i32 s16, s16, s43
    s_lshl_b32 s15, s15, 10
    s_add_u32 s15, s15, s16
    s_add_u32 s15, s15, s68
    v_mfma_f32_16x16x32_bf16 v[136:139], v[120:123], v[12:15], 0
    buffer_store_dwordx4 v[120:123], v6, s[4:7], s15 offen sc1
    s_add_u32 s69, s69, 1
    v_lshl_or_b32 v124, v89, 16, v88
    v_lshl_or_b32 v125, v91, 16, v90
    v_lshl_or_b32 v126, v93, 16, v92
    v_lshl_or_b32 v127, v95, 16, v94
    s_sub_i32 s15, s69, 84
    s_max_i32 s15, s15, 0
    s_mul_i32 s15, s15, 43
    s_lshr_b32 s15, s15, 8
    s_add_u32 s15, s15, s69
    s_mul_i32 s16, s15, s71
    s_lshr_b32 s16, s16, 16
    s_mul_i32 s17, s16, s70
    s_sub_u32 s15, s15, s17
    s_mul_i32 s16, s16, s43
    s_lshl_b32 s15, s15, 10
    s_add_u32 s15, s15, s16
    s_add_u32 s15, s15, s68
    v_mfma_f32_16x16x32_bf16 v[140:143], v[124:127], v[12:15], 0
    buffer_store_dwordx4 v[124:127], v6, s[4:7], s15 offen sc1
    s_add_u32 s69, s69, 1
    s_nop 7
    s_mov_b32 exec_lo, 0x00010001
    s_mov_b32 exec_hi, 0x00010001
    buffer_store_dwordx4 v[128:131], v11, s[4:7], s45 offen offset:0 sc1
    buffer_store_dwordx4 v[132:135], v11, s[4:7], s45 offen offset:64 sc1
    buffer_store_dwordx4 v[136:139], v11, s[4:7], s45 offen offset:128 sc1
    buffer_store_dwordx4 v[140:143], v11, s[4:7], s45 offen offset:192 sc1
    s_mov_b64 exec, -1
    s_mul_i32 s41, s2, 5
    s_add_u32 s41, s41, 3
    s_mov_b32 s28, s82
    s_mov_b32 s29, s83
    s_mov_b32 s30, 819200
    s_mov_b32 s31, 0x00020000
    s_mov_b32 s32, 1280
    s_mov_b32 s70, 5
    s_mov_b32 s71, 13108
    s_mov_b32 s43, 102400
    s_mov_b32 s68, 15728640
    s_mov_b32 s15, s41
    s_cmp_lt_u32 s41, 200
    s_cbranch_scc1 sequential_preLN__grouped_kv_mqa__dense_activation_silu__prompt_kernel_j3_rp10
    s_cmp_lt_u32 s41, 740
    s_cbranch_scc1 sequential_preLN__grouped_kv_mqa__dense_activation_silu__prompt_kernel_j3_rpw1
    s_mov_b32 s28, s86
    s_mov_b32 s29, s87
    s_mov_b32 s30, 2211840
    s_mov_b32 s43, 276480
    s_mov_b32 s68, 19398656
    s_sub_u32 s15, s41, 740
sequential_preLN__grouped_kv_mqa__dense_activation_silu__prompt_kernel_j3_rp10:
    s_mul_i32 s33, s15, 6554
    s_lshr_b32 s33, s33, 16
    s_mul_i32 s16, s33, 10
    s_sub_u32 s69, s15, s16
    s_branch sequential_preLN__grouped_kv_mqa__dense_activation_silu__prompt_kernel_j3_rpgo
sequential_preLN__grouped_kv_mqa__dense_activation_silu__prompt_kernel_j3_rpw1:
    s_mov_b32 s28, s84
    s_mov_b32 s29, s85
    s_mov_b32 s30, 2211840
    s_mov_b32 s32, 3456
    s_mov_b32 s70, 7
    s_mov_b32 s71, 9363
    s_mov_b32 s43, 143360
    s_mov_b32 s68, 16777216
    s_sub_u32 s15, s41, 200
    s_mul_i32 s33, s15, 2428
    s_lshr_b32 s33, s33, 16
    s_mul_i32 s16, s33, 27
    s_sub_u32 s69, s15, s16
sequential_preLN__grouped_kv_mqa__dense_activation_silu__prompt_kernel_j3_rpgo:
    s_lshl_b32 s15, s32, 3
    v_mul_lo_u32 v2, v3, s15
    v_lshl_add_u32 v2, v4, 1, v2
    s_mul_i32 s15, s33, s32
    s_lshl_b32 s15, s15, 5
    s_lshl_b32 s16, s69, 7
    s_add_u32 s15, s15, s16
    buffer_load_ushort v64, v2, s[28:31], s15 offen offset:0
    buffer_load_ushort v72, v2, s[28:31], s15 offen offset:32
    buffer_load_ushort v80, v2, s[28:31], s15 offen offset:64
    buffer_load_ushort v88, v2, s[28:31], s15 offen offset:96
    s_add_u32 s15, s15, s32
    buffer_load_ushort v65, v2, s[28:31], s15 offen offset:0
    buffer_load_ushort v73, v2, s[28:31], s15 offen offset:32
    buffer_load_ushort v81, v2, s[28:31], s15 offen offset:64
    buffer_load_ushort v89, v2, s[28:31], s15 offen offset:96
    s_add_u32 s15, s15, s32
    buffer_load_ushort v66, v2, s[28:31], s15 offen offset:0
    buffer_load_ushort v74, v2, s[28:31], s15 offen offset:32
    buffer_load_ushort v82, v2, s[28:31], s15 offen offset:64
    buffer_load_ushort v90, v2, s[28:31], s15 offen offset:96
    s_add_u32 s15, s15, s32
    buffer_load_ushort v67, v2, s[28:31], s15 offen offset:0
    buffer_load_ushort v75, v2, s[28:31], s15 offen offset:32
    buffer_load_ushort v83, v2, s[28:31], s15 offen offset:64
    buffer_load_ushort v91, v2, s[28:31], s15 offen offset:96
    s_add_u32 s15, s15, s32
    buffer_load_ushort v68, v2, s[28:31], s15 offen offset:0
    buffer_load_ushort v76, v2, s[28:31], s15 offen offset:32
    buffer_load_ushort v84, v2, s[28:31], s15 offen offset:64
    buffer_load_ushort v92, v2, s[28:31], s15 offen offset:96
    s_add_u32 s15, s15, s32
    buffer_load_ushort v69, v2, s[28:31], s15 offen offset:0
    buffer_load_ushort v77, v2, s[28:31], s15 offen offset:32
    buffer_load_ushort v85, v2, s[28:31], s15 offen offset:64
    buffer_load_ushort v93, v2, s[28:31], s15 offen offset:96
    s_add_u32 s15, s15, s32
    buffer_load_ushort v70, v2, s[28:31], s15 offen offset:0
    buffer_load_ushort v78, v2, s[28:31], s15 offen offset:32
    buffer_load_ushort v86, v2, s[28:31], s15 offen offset:64
    buffer_load_ushort v94, v2, s[28:31], s15 offen offset:96
    s_add_u32 s15, s15, s32
    buffer_load_ushort v71, v2, s[28:31], s15 offen offset:0
    buffer_load_ushort v79, v2, s[28:31], s15 offen offset:32
    buffer_load_ushort v87, v2, s[28:31], s15 offen offset:64
    buffer_load_ushort v95, v2, s[28:31], s15 offen offset:96
    s_mul_i32 s17, s33, s70
    s_lshl_b32 s17, s17, 10
    s_add_u32 s68, s68, s17
    s_cmp_eq_u32 s70, 7
    s_cselect_b32 s17, s33, 20
    s_mul_i32 s17, s17, 7168
    s_lshl_b32 s16, s69, 8
    s_add_u32 s17, s17, s16
    s_add_u32 s45, s17, 1048576
    s_lshl_b32 s69, s69, 2
    s_waitcnt vmcnt(32)
    v_lshl_or_b32 v96, v33, 16, v32
    v_lshl_or_b32 v97, v35, 16, v34
    v_lshl_or_b32 v98, v37, 16, v36
    v_lshl_or_b32 v99, v39, 16, v38
    s_sub_i32 s15, s64, 84
    s_max_i32 s15, s15, 0
    s_mul_i32 s15, s15, 43
    s_lshr_b32 s15, s15, 8
    s_add_u32 s15, s15, s64
    s_mul_i32 s16, s15, s66
    s_lshr_b32 s16, s16, 16
    s_mul_i32 s17, s16, s65
    s_sub_u32 s15, s15, s17
    s_mul_i32 s16, s16, s67
    s_lshl_b32 s15, s15, 10
    s_add_u32 s15, s15, s16
    s_add_u32 s15, s15, s63
    v_mfma_f32_16x16x32_bf16 v[128:131], v[96:99], v[12:15], 0
    buffer_store_dwordx4 v[96:99], v6, s[4:7], s15 offen sc1
    s_add_u32 s64, s64, 1
    v_lshl_or_b32 v100, v41, 16, v40
    v_lshl_or_b32 v101, v43, 16, v42
    v_lshl_or_b32 v102, v45, 16, v44
    v_lshl_or_b32 v103, v47, 16, v46
    s_sub_i32 s15, s64, 84
    s_max_i32 s15, s15, 0
    s_mul_i32 s15, s15, 43
    s_lshr_b32 s15, s15, 8
    s_add_u32 s15, s15, s64
    s_mul_i32 s16, s15, s66
    s_lshr_b32 s16, s16, 16
    s_mul_i32 s17, s16, s65
    s_sub_u32 s15, s15, s17
    s_mul_i32 s16, s16, s67
    s_lshl_b32 s15, s15, 10
    s_add_u32 s15, s15, s16
    s_add_u32 s15, s15, s63
    v_mfma_f32_16x16x32_bf16 v[132:135], v[100:103], v[12:15], 0
    buffer_store_dwordx4 v[100:103], v6, s[4:7], s15 offen sc1
    s_add_u32 s64, s64, 1
    v_lshl_or_b32 v104, v49, 16, v48
    v_lshl_or_b32 v105, v51, 16, v50
    v_lshl_or_b32 v106, v53, 16, v52
    v_lshl_or_b32 v107, v55, 16, v54
    s_sub_i32 s15, s64, 84
    s_max_i32 s15, s15, 0
    s_mul_i32 s15, s15, 43
    s_lshr_b32 s15, s15, 8
    s_add_u32 s15, s15, s64
    s_mul_i32 s16, s15, s66
    s_lshr_b32 s16, s16, 16
    s_mul_i32 s17, s16, s65
    s_sub_u32 s15, s15, s17
    s_mul_i32 s16, s16, s67
    s_lshl_b32 s15, s15, 10
    s_add_u32 s15, s15, s16
    s_add_u32 s15, s15, s63
    v_mfma_f32_16x16x32_bf16 v[136:139], v[104:107], v[12:15], 0
    buffer_store_dwordx4 v[104:107], v6, s[4:7], s15 offen sc1
    s_add_u32 s64, s64, 1
    v_lshl_or_b32 v108, v57, 16, v56
    v_lshl_or_b32 v109, v59, 16, v58
    v_lshl_or_b32 v110, v61, 16, v60
    v_lshl_or_b32 v111, v63, 16, v62
    s_sub_i32 s15, s64, 84
    s_max_i32 s15, s15, 0
    s_mul_i32 s15, s15, 43
    s_lshr_b32 s15, s15, 8
    s_add_u32 s15, s15, s64
    s_mul_i32 s16, s15, s66
    s_lshr_b32 s16, s16, 16
    s_mul_i32 s17, s16, s65
    s_sub_u32 s15, s15, s17
    s_mul_i32 s16, s16, s67
    s_lshl_b32 s15, s15, 10
    s_add_u32 s15, s15, s16
    s_add_u32 s15, s15, s63
    v_mfma_f32_16x16x32_bf16 v[140:143], v[108:111], v[12:15], 0
    buffer_store_dwordx4 v[108:111], v6, s[4:7], s15 offen sc1
    s_add_u32 s64, s64, 1
    s_nop 7
    s_mov_b32 exec_lo, 0x00010001
    s_mov_b32 exec_hi, 0x00010001
    buffer_store_dwordx4 v[128:131], v11, s[4:7], s44 offen offset:0 sc1
    buffer_store_dwordx4 v[132:135], v11, s[4:7], s44 offen offset:64 sc1
    buffer_store_dwordx4 v[136:139], v11, s[4:7], s44 offen offset:128 sc1
    buffer_store_dwordx4 v[140:143], v11, s[4:7], s44 offen offset:192 sc1
    s_mov_b64 exec, -1
    s_mul_i32 s41, s2, 5
    s_add_u32 s41, s41, 4
    s_mov_b32 s28, s82
    s_mov_b32 s29, s83
    s_mov_b32 s30, 819200
    s_mov_b32 s31, 0x00020000
    s_mov_b32 s32, 1280
    s_mov_b32 s65, 5
    s_mov_b32 s66, 13108
    s_mov_b32 s67, 102400
    s_mov_b32 s63, 15728640
    s_mov_b32 s15, s41
    s_cmp_lt_u32 s41, 200
    s_cbranch_scc1 sequential_preLN__grouped_kv_mqa__dense_activation_silu__prompt_kernel_j4_rp10
    s_cmp_lt_u32 s41, 740
    s_cbranch_scc1 sequential_preLN__grouped_kv_mqa__dense_activation_silu__prompt_kernel_j4_rpw1
    s_mov_b32 s28, s86
    s_mov_b32 s29, s87
    s_mov_b32 s30, 2211840
    s_mov_b32 s67, 276480
    s_mov_b32 s63, 19398656
    s_sub_u32 s15, s41, 740
sequential_preLN__grouped_kv_mqa__dense_activation_silu__prompt_kernel_j4_rp10:
    s_mul_i32 s33, s15, 6554
    s_lshr_b32 s33, s33, 16
    s_mul_i32 s16, s33, 10
    s_sub_u32 s64, s15, s16
    s_branch sequential_preLN__grouped_kv_mqa__dense_activation_silu__prompt_kernel_j4_rpgo
sequential_preLN__grouped_kv_mqa__dense_activation_silu__prompt_kernel_j4_rpw1:
    s_mov_b32 s28, s84
    s_mov_b32 s29, s85
    s_mov_b32 s30, 2211840
    s_mov_b32 s32, 3456
    s_mov_b32 s65, 7
    s_mov_b32 s66, 9363
    s_mov_b32 s67, 143360
    s_mov_b32 s63, 16777216
    s_sub_u32 s15, s41, 200
    s_mul_i32 s33, s15, 2428
    s_lshr_b32 s33, s33, 16
    s_mul_i32 s16, s33, 27
    s_sub_u32 s64, s15, s16
sequential_preLN__grouped_kv_mqa__dense_activation_silu__prompt_kernel_j4_rpgo:
    s_lshl_b32 s15, s32, 3
    v_mul_lo_u32 v2, v3, s15
    v_lshl_add_u32 v2, v4, 1, v2
    s_mul_i32 s15, s33, s32
    s_lshl_b32 s15, s15, 5
    s_lshl_b32 s16, s64, 7
    s_add_u32 s15, s15, s16
    buffer_load_ushort v32, v2, s[28:31], s15 offen offset:0
    buffer_load_ushort v40, v2, s[28:31], s15 offen offset:32
    buffer_load_ushort v48, v2, s[28:31], s15 offen offset:64
    buffer_load_ushort v56, v2, s[28:31], s15 offen offset:96
    s_add_u32 s15, s15, s32
    buffer_load_ushort v33, v2, s[28:31], s15 offen offset:0
    buffer_load_ushort v41, v2, s[28:31], s15 offen offset:32
    buffer_load_ushort v49, v2, s[28:31], s15 offen offset:64
    buffer_load_ushort v57, v2, s[28:31], s15 offen offset:96
    s_add_u32 s15, s15, s32
    buffer_load_ushort v34, v2, s[28:31], s15 offen offset:0
    buffer_load_ushort v42, v2, s[28:31], s15 offen offset:32
    buffer_load_ushort v50, v2, s[28:31], s15 offen offset:64
    buffer_load_ushort v58, v2, s[28:31], s15 offen offset:96
    s_add_u32 s15, s15, s32
    buffer_load_ushort v35, v2, s[28:31], s15 offen offset:0
    buffer_load_ushort v43, v2, s[28:31], s15 offen offset:32
    buffer_load_ushort v51, v2, s[28:31], s15 offen offset:64
    buffer_load_ushort v59, v2, s[28:31], s15 offen offset:96
    s_add_u32 s15, s15, s32
    buffer_load_ushort v36, v2, s[28:31], s15 offen offset:0
    buffer_load_ushort v44, v2, s[28:31], s15 offen offset:32
    buffer_load_ushort v52, v2, s[28:31], s15 offen offset:64
    buffer_load_ushort v60, v2, s[28:31], s15 offen offset:96
    s_add_u32 s15, s15, s32
    buffer_load_ushort v37, v2, s[28:31], s15 offen offset:0
    buffer_load_ushort v45, v2, s[28:31], s15 offen offset:32
    buffer_load_ushort v53, v2, s[28:31], s15 offen offset:64
    buffer_load_ushort v61, v2, s[28:31], s15 offen offset:96
    s_add_u32 s15, s15, s32
    buffer_load_ushort v38, v2, s[28:31], s15 offen offset:0
    buffer_load_ushort v46, v2, s[28:31], s15 offen offset:32
    buffer_load_ushort v54, v2, s[28:31], s15 offen offset:64
    buffer_load_ushort v62, v2, s[28:31], s15 offen offset:96
    s_add_u32 s15, s15, s32
    buffer_load_ushort v39, v2, s[28:31], s15 offen offset:0
    buffer_load_ushort v47, v2, s[28:31], s15 offen offset:32
    buffer_load_ushort v55, v2, s[28:31], s15 offen offset:64
    buffer_load_ushort v63, v2, s[28:31], s15 offen offset:96
    s_mul_i32 s17, s33, s65
    s_lshl_b32 s17, s17, 10
    s_add_u32 s63, s63, s17
    s_cmp_eq_u32 s65, 7
    s_cselect_b32 s17, s33, 20
    s_mul_i32 s17, s17, 7168
    s_lshl_b32 s16, s64, 8
    s_add_u32 s17, s17, s16
    s_add_u32 s44, s17, 1048576
    s_lshl_b32 s64, s64, 2
    s_waitcnt vmcnt(32)
    v_lshl_or_b32 v112, v65, 16, v64
    v_lshl_or_b32 v113, v67, 16, v66
    v_lshl_or_b32 v114, v69, 16, v68
    v_lshl_or_b32 v115, v71, 16, v70
    s_sub_i32 s15, s69, 84
    s_max_i32 s15, s15, 0
    s_mul_i32 s15, s15, 43
    s_lshr_b32 s15, s15, 8
    s_add_u32 s15, s15, s69
    s_mul_i32 s16, s15, s71
    s_lshr_b32 s16, s16, 16
    s_mul_i32 s17, s16, s70
    s_sub_u32 s15, s15, s17
    s_mul_i32 s16, s16, s43
    s_lshl_b32 s15, s15, 10
    s_add_u32 s15, s15, s16
    s_add_u32 s15, s15, s68
    v_mfma_f32_16x16x32_bf16 v[128:131], v[112:115], v[12:15], 0
    buffer_store_dwordx4 v[112:115], v6, s[4:7], s15 offen sc1
    s_add_u32 s69, s69, 1
    v_lshl_or_b32 v116, v73, 16, v72
    v_lshl_or_b32 v117, v75, 16, v74
    v_lshl_or_b32 v118, v77, 16, v76
    v_lshl_or_b32 v119, v79, 16, v78
    s_sub_i32 s15, s69, 84
    s_max_i32 s15, s15, 0
    s_mul_i32 s15, s15, 43
    s_lshr_b32 s15, s15, 8
    s_add_u32 s15, s15, s69
    s_mul_i32 s16, s15, s71
    s_lshr_b32 s16, s16, 16
    s_mul_i32 s17, s16, s70
    s_sub_u32 s15, s15, s17
    s_mul_i32 s16, s16, s43
    s_lshl_b32 s15, s15, 10
    s_add_u32 s15, s15, s16
    s_add_u32 s15, s15, s68
    v_mfma_f32_16x16x32_bf16 v[132:135], v[116:119], v[12:15], 0
    buffer_store_dwordx4 v[116:119], v6, s[4:7], s15 offen sc1
    s_add_u32 s69, s69, 1
    v_lshl_or_b32 v120, v81, 16, v80
    v_lshl_or_b32 v121, v83, 16, v82
    v_lshl_or_b32 v122, v85, 16, v84
    v_lshl_or_b32 v123, v87, 16, v86
    s_sub_i32 s15, s69, 84
    s_max_i32 s15, s15, 0
    s_mul_i32 s15, s15, 43
    s_lshr_b32 s15, s15, 8
    s_add_u32 s15, s15, s69
    s_mul_i32 s16, s15, s71
    s_lshr_b32 s16, s16, 16
    s_mul_i32 s17, s16, s70
    s_sub_u32 s15, s15, s17
    s_mul_i32 s16, s16, s43
    s_lshl_b32 s15, s15, 10
    s_add_u32 s15, s15, s16
    s_add_u32 s15, s15, s68
    v_mfma_f32_16x16x32_bf16 v[136:139], v[120:123], v[12:15], 0
    buffer_store_dwordx4 v[120:123], v6, s[4:7], s15 offen sc1
    s_add_u32 s69, s69, 1
    v_lshl_or_b32 v124, v89, 16, v88
    v_lshl_or_b32 v125, v91, 16, v90
    v_lshl_or_b32 v126, v93, 16, v92
    v_lshl_or_b32 v127, v95, 16, v94
    s_sub_i32 s15, s69, 84
    s_max_i32 s15, s15, 0
    s_mul_i32 s15, s15, 43
    s_lshr_b32 s15, s15, 8
    s_add_u32 s15, s15, s69
    s_mul_i32 s16, s15, s71
    s_lshr_b32 s16, s16, 16
    s_mul_i32 s17, s16, s70
    s_sub_u32 s15, s15, s17
    s_mul_i32 s16, s16, s43
    s_lshl_b32 s15, s15, 10
    s_add_u32 s15, s15, s16
    s_add_u32 s15, s15, s68
    v_mfma_f32_16x16x32_bf16 v[140:143], v[124:127], v[12:15], 0
    buffer_store_dwordx4 v[124:127], v6, s[4:7], s15 offen sc1
    s_add_u32 s69, s69, 1
    s_nop 7
    s_mov_b32 exec_lo, 0x00010001
    s_mov_b32 exec_hi, 0x00010001
    buffer_store_dwordx4 v[128:131], v11, s[4:7], s45 offen offset:0 sc1
    buffer_store_dwordx4 v[132:135], v11, s[4:7], s45 offen offset:64 sc1
    buffer_store_dwordx4 v[136:139], v11, s[4:7], s45 offen offset:128 sc1
    buffer_store_dwordx4 v[140:143], v11, s[4:7], s45 offen offset:192 sc1
    s_mov_b64 exec, -1
    s_waitcnt vmcnt(0)
    v_lshl_or_b32 v96, v33, 16, v32
    v_lshl_or_b32 v97, v35, 16, v34
    v_lshl_or_b32 v98, v37, 16, v36
    v_lshl_or_b32 v99, v39, 16, v38
    s_sub_i32 s15, s64, 84
    s_max_i32 s15, s15, 0
    s_mul_i32 s15, s15, 43
    s_lshr_b32 s15, s15, 8
    s_add_u32 s15, s15, s64
    s_mul_i32 s16, s15, s66
    s_lshr_b32 s16, s16, 16
    s_mul_i32 s17, s16, s65
    s_sub_u32 s15, s15, s17
    s_mul_i32 s16, s16, s67
    s_lshl_b32 s15, s15, 10
    s_add_u32 s15, s15, s16
    s_add_u32 s15, s15, s63
    v_mfma_f32_16x16x32_bf16 v[128:131], v[96:99], v[12:15], 0
    buffer_store_dwordx4 v[96:99], v6, s[4:7], s15 offen sc1
    s_add_u32 s64, s64, 1
    v_lshl_or_b32 v100, v41, 16, v40
    v_lshl_or_b32 v101, v43, 16, v42
    v_lshl_or_b32 v102, v45, 16, v44
    v_lshl_or_b32 v103, v47, 16, v46
    s_sub_i32 s15, s64, 84
    s_max_i32 s15, s15, 0
    s_mul_i32 s15, s15, 43
    s_lshr_b32 s15, s15, 8
    s_add_u32 s15, s15, s64
    s_mul_i32 s16, s15, s66
    s_lshr_b32 s16, s16, 16
    s_mul_i32 s17, s16, s65
    s_sub_u32 s15, s15, s17
    s_mul_i32 s16, s16, s67
    s_lshl_b32 s15, s15, 10
    s_add_u32 s15, s15, s16
    s_add_u32 s15, s15, s63
    v_mfma_f32_16x16x32_bf16 v[132:135], v[100:103], v[12:15], 0
    buffer_store_dwordx4 v[100:103], v6, s[4:7], s15 offen sc1
    s_add_u32 s64, s64, 1
    v_lshl_or_b32 v104, v49, 16, v48
    v_lshl_or_b32 v105, v51, 16, v50
    v_lshl_or_b32 v106, v53, 16, v52
    v_lshl_or_b32 v107, v55, 16, v54
    s_sub_i32 s15, s64, 84
    s_max_i32 s15, s15, 0
    s_mul_i32 s15, s15, 43
    s_lshr_b32 s15, s15, 8
    s_add_u32 s15, s15, s64
    s_mul_i32 s16, s15, s66
    s_lshr_b32 s16, s16, 16
    s_mul_i32 s17, s16, s65
    s_sub_u32 s15, s15, s17
    s_mul_i32 s16, s16, s67
    s_lshl_b32 s15, s15, 10
    s_add_u32 s15, s15, s16
    s_add_u32 s15, s15, s63
    v_mfma_f32_16x16x32_bf16 v[136:139], v[104:107], v[12:15], 0
    buffer_store_dwordx4 v[104:107], v6, s[4:7], s15 offen sc1
    s_add_u32 s64, s64, 1
    v_lshl_or_b32 v108, v57, 16, v56
    v_lshl_or_b32 v109, v59, 16, v58
    v_lshl_or_b32 v110, v61, 16, v60
    v_lshl_or_b32 v111, v63, 16, v62
    s_sub_i32 s15, s64, 84
    s_max_i32 s15, s15, 0
    s_mul_i32 s15, s15, 43
    s_lshr_b32 s15, s15, 8
    s_add_u32 s15, s15, s64
    s_mul_i32 s16, s15, s66
    s_lshr_b32 s16, s16, 16
    s_mul_i32 s17, s16, s65
    s_sub_u32 s15, s15, s17
    s_mul_i32 s16, s16, s67
    s_lshl_b32 s15, s15, 10
    s_add_u32 s15, s15, s16
    s_add_u32 s15, s15, s63
    v_mfma_f32_16x16x32_bf16 v[140:143], v[108:111], v[12:15], 0
    buffer_store_dwordx4 v[108:111], v6, s[4:7], s15 offen sc1
    s_add_u32 s64, s64, 1
    s_nop 7
    s_mov_b32 exec_lo, 0x00010001
    s_mov_b32 exec_hi, 0x00010001
    buffer_store_dwordx4 v[128:131], v11, s[4:7], s44 offen offset:0 sc1
    buffer_store_dwordx4 v[132:135], v11, s[4:7], s44 offen offset:64 sc1
    buffer_store_dwordx4 v[136:139], v11, s[4:7], s44 offen offset:128 sc1
    buffer_store_dwordx4 v[140:143], v11, s[4:7], s44 offen offset:192 sc1
    s_mov_b64 exec, -1
    s_waitcnt vmcnt(0)
    s_lshl_b32 s15, s2, 7
    s_add_u32 s15, s15, 23724032
    v_lshlrev_b32 v2, 15, v1
    v_mov_b32 v3, s100
    s_mov_b64 exec, 0xff
    buffer_store_dword v3, v2, s[4:7], s15 offen sc1
    s_mov_b64 exec, -1
    s_lshl_b32 s15, s60, 15
    s_add_u32 s15, s15, 23724032
    s_mov_b32 s39, 524288
    v_lshlrev_b32 v24, 7, v1
    v_lshlrev_b32 v25, 7, v1
    v_add_u32 v25, 8192, v25
    v_lshlrev_b32 v26, 7, v1
    v_add_u32 v26, 16384, v26
    v_lshlrev_b32 v27, 7, v1
    v_add_u32 v27, 24576, v27
sequential_preLN__grouped_kv_mqa__dense_activation_silu__prompt_kernel_polls:
    buffer_load_dword v20, v24, s[4:7], s15 offen sc1
    buffer_load_dword v21, v25, s[4:7], s15 offen sc1
    buffer_load_dword v22, v26, s[4:7], s15 offen sc1
    buffer_load_dword v23, v27, s[4:7], s15 offen sc1
sequential_preLN__grouped_kv_mqa__dense_activation_silu__prompt_kernel_pollws:
    s_waitcnt vmcnt(0)
    v_xor_b32 v28, s100, v20
    v_xor_b32 v29, s100, v21
    v_or_b32 v28, v28, v29
    v_xor_b32 v29, s100, v22
    v_or_b32 v28, v28, v29
    v_xor_b32 v29, s100, v23
    v_or_b32 v28, v28, v29
    v_cmp_ne_u32 vcc, 0, v28
    s_sub_u32 s39, s39, 1
    s_cbranch_scc1 sequential_preLN__grouped_kv_mqa__dense_activation_silu__prompt_kernel_pollxs
    s_nop 1
    s_cmp_eq_u64 vcc, 0
    s_cbranch_scc1 sequential_preLN__grouped_kv_mqa__dense_activation_silu__prompt_kernel_pollxs
    s_sleep 2
    s_branch sequential_preLN__grouped_kv_mqa__dense_activation_silu__prompt_kernel_polls
sequential_preLN__grouped_kv_mqa__dense_activation_silu__prompt_kernel_pollxs:
    s_mov_b64 exec, -1
    v_lshlrev_b32 v2, 7, v1
    s_and_b32 s17, s2, 1
    s_mul_i32 s15, s61, 25600
    s_add_u32 s15, s15, 15728640
    buffer_load_dword v32, v2, s[4:7], s15 offen
    s_add_u32 s15, s15, 8192
    buffer_load_dword v33, v2, s[4:7], s15 offen
    s_add_u32 s15, s15, 8192
    buffer_load_dword v34, v2, s[4:7], s15 offen
    s_add_u32 s15, s15, 1024
    buffer_load_dword v35, v2, s[4:7], s15 offen
    s_add_u32 s15, s15, 8192
    s_mul_i32 s15, s61, 71680
    s_add_u32 s15, s15, 16777216
    buffer_load_dword v32, v2, s[4:7], s15 offen
    s_add_u32 s15, s15, 8192
    buffer_load_dword v33, v2, s[4:7], s15 offen
    s_add_u32 s15, s15, 8192
    buffer_load_dword v34, v2, s[4:7], s15 offen
    s_add_u32 s15, s15, 8192
    buffer_load_dword v35, v2, s[4:7], s15 offen
    s_add_u32 s15, s15, 8192
    buffer_load_dword v36, v2, s[4:7], s15 offen
    s_add_u32 s15, s15, 8192
    buffer_load_dword v37, v2, s[4:7], s15 offen
    s_add_u32 s15, s15, 8192
    buffer_load_dword v38, v2, s[4:7], s15 offen
    s_add_u32 s15, s15, 8192
    buffer_load_dword v39, v2, s[4:7], s15 offen
    s_add_u32 s15, s15, 6144
    buffer_load_dword v40, v2, s[4:7], s15 offen
    s_add_u32 s15, s15, 8192
    s_waitcnt vmcnt(0)
    s_endpgm
sequential_preLN__grouped_kv_mqa__dense_activation_silu__prompt_kernel_att:
    s_lshl_b32 s17, s60, 2
    s_lshr_b32 s12, s61, 3
    s_add_u32 s12, s12, s17
    s_and_b32 s13, s61, 7
    s_lshr_b32 s15, s3, 1
    s_lshl_b32 s14, s13, 2
    s_add_u32 s14, s14, s15
    s_and_b32 s15, s3, 1
    s_lshl_b32 s23, s12, 1
    s_add_u32 s23, s23, s15
    s_mul_i32 s22, s15, 5376
    s_lshr_b32 s15, s3, 1
    s_mul_i32 s15, s15, 40
    s_add_u32 s22, s22, s15
    s_add_u32 s22, s22, 112640
    v_lshrrev_b32 v7, 5, v1
    v_and_b32 v8, 31, v1
    v_mul_u32_u24 v3, 168, v8
    v_add_u32 v3, s22, v3
    v_lshl_add_u32 v2, v7, 4, v3
    v_mov_b32 v4, 163776
    ds_read_b64 v[12:13], v2
    ds_read_b64 v[14:15], v2 offset:8
    ds_read_b64 v[16:17], v3 offset:32
    ds_read_b32 v26, v4
    s_mov_b32 s4, s76
    s_mov_b32 s5, s77
    s_mov_b32 s6, 25165824
    s_mov_b32 s7, 0x00020000
    s_mov_b32 s20, 0x000fffff
    s_mov_b32 s21, 0x000fffff
    s_mov_b32 s26, -1
    s_mov_b32 s27, 0
    v_mov_b32 v2, 0x3f803f80
    v_cmp_eq_u32 vcc, 20, v8
    v_mov_b32 v24, 0x3f803f80
    v_mov_b32 v25, 0x00003f80
    v_cndmask_b32 v2, 0, v2, vcc
    v_mov_b32 v40, v2
    v_mov_b32 v41, v2
    v_mov_b32 v42, v2
    v_mov_b32 v43, v2
    v_mov_b32 v44, v2
    v_mov_b32 v45, v2
    v_mov_b32 v46, v2
    v_mov_b32 v47, v2
    v_mov_b32 v48, v2
    v_mov_b32 v49, v2
    v_mov_b32 v50, v2
    v_mov_b32 v51, v2
    v_mov_b32 v52, v2
    v_mov_b32 v53, v2
    v_mov_b32 v54, v2
    v_mov_b32 v55, v2
    s_cmp_ge_u32 s3, 4
    s_cbranch_scc0 sequential_preLN__grouped_kv_mqa__dense_activation_silu__prompt_kernel_np
    s_setprio 1
sequential_preLN__grouped_kv_mqa__dense_activation_silu__prompt_kernel_np:
    s_waitcnt lgkmcnt(0)
    s_mov_b32 exec_lo, 0
    v_mov_b32 v16, 0
    v_mov_b32 v17, 0
    s_mov_b32 exec_lo, -1
    v_mov_b32 v2, 0
    v_dot2_f32_bf16 v2, v12, v12, v2
    v_dot2_f32_bf16 v2, v13, v13, v2
    v_dot2_f32_bf16 v2, v14, v14, v2
    v_dot2_f32_bf16 v2, v15, v15, v2
    v_dot2_f32_bf16 v2, v16, v16, v2
    v_dot2_f32_bf16 v2, v17, v17, v2
    s_nop 2
    v_mov_b32 v3, v2
    s_nop 1
    v_permlane32_swap_b32 v2, v3
    s_nop 1
    v_add_f32 v2, v2, v3
    v_mul_f32 v2, v2, v26
    v_sqrt_f32 v2, v2
    s_mov_b32 s18, 0
    s_mov_b32 s19, 0
    s_mov_b32 s42, 69642
    v_mul_f32 v2, 0xbf828f5c, v2
    s_barrier
sequential_preLN__grouped_kv_mqa__dense_activation_silu__prompt_kernel_start:
    v_lshlrev_b32 v10, 3, v8
    v_mov_b32 v9, v6
    ds_read_b128 v[20:23], v6
    s_mov_b64 exec, s[26:27]
    ds_read_b64 v[24:25], v10 offset:1024
    s_mov_b32 exec_lo, 0
    s_mov_b32 exec_hi, -1
    v_cvt_pk_bf16_f32 v3, v2, v2
    v_and_b32 v3, 0xffff0000, v3
    v_sub_f32 v2, v2, v3
    v_cvt_pk_bf16_f32 v4, v2, v2
    v_and_b32 v4, 0xffff0000, v4
    v_sub_f32 v2, v2, v4
    v_cvt_pk_bf16_f32 v17, v2, 0
    v_lshrrev_b32 v3, 16, v3
    v_or_b32 v16, v3, v4
    s_mov_b64 exec, -1
    v_mul_u32_u24 v11, 320, v7
    v_lshl_add_u32 v11, v8, 4, v11
    v_mov_b32 v96, 0
    v_mov_b32 v97, 0
    v_mov_b32 v98, 0
    v_mov_b32 v99, 0
    v_mov_b32 v100, 0
    v_mov_b32 v101, 0
    v_mov_b32 v102, 0
    v_mov_b32 v103, 0
    v_mov_b32 v104, 0
    v_mov_b32 v105, 0
    v_mov_b32 v106, 0
    v_mov_b32 v107, 0
    v_mov_b32 v108, 0
    v_mov_b32 v109, 0
    v_mov_b32 v110, 0
    v_mov_b32 v111, 0
    s_waitcnt lgkmcnt(0)
    v_mfma_f32_32x32x16_bf16 v[64:79], v[20:23], v[12:15], 0
    v_mfma_f32_32x32x8_bf16 v[64:79], v[24:25], v[16:17], v[64:79]
    ds_read_b128 v[20:23], v9 offset:2560
    s_mov_b64 exec, s[20:21]
    ds_read_b128 v[40:43], v11 offset:1280
    ds_read_b128 v[44:47], v11 offset:1920
    s_mov_b64 exec, s[26:27]
    ds_read_b64 v[24:25], v10 offset:3584
    s_mov_b64 exec, -1
    s_nop 4
    s_branch sequential_preLN__grouped_kv_mqa__dense_activation_silu__prompt_kernel_loop
.p2alignl 6, 0xBF800000
sequential_preLN__grouped_kv_mqa__dense_activation_silu__prompt_kernel_loop:
    v_exp_f32_e64 v64, v64
    v_exp_f32 v65, v65
    v_exp_f32 v66, v66
    v_exp_f32 v67, v67
    s_waitcnt lgkmcnt(3)
    v_mfma_f32_32x32x16_bf16 v[80:95], v[20:23], v[12:15], 0
    ds_read_b128 v[20:23], v9 offset:5120
    v_exp_f32_e64 v68, v68
    v_exp_f32 v69, v69
    v_exp_f32 v70, v70
    v_exp_f32 v71, v71
    s_waitcnt lgkmcnt(1)
    v_cvt_pk_bf16_f32 v32, v64, v65
    v_cvt_pk_bf16_f32 v33, v66, v67
    v_mfma_f32_32x32x8_bf16 v[80:95], v[24:25], v[16:17], v[80:95]
    v_cvt_pk_bf16_f32 v34, v68, v69
    v_cvt_pk_bf16_f32 v35, v70, v71
    v_exp_f32 v72, v72
    v_exp_f32 v73, v73
    v_exp_f32 v74, v74
    v_exp_f32 v75, v75
    v_mfma_f32_32x32x16_bf16 v[96:111], v[40:43], v[32:35], v[96:111]
    v_exp_f32 v76, v76
    v_exp_f32 v77, v77
    v_exp_f32 v78, v78
    v_exp_f32 v79, v79
    v_cvt_pk_bf16_f32 v36, v72, v73
    v_cvt_pk_bf16_f32 v37, v74, v75
    v_cvt_pk_bf16_f32 v38, v76, v77
    v_cvt_pk_bf16_f32 v39, v78, v79
    s_or_b64 exec, s[20:21], 0x41
    ds_read_b128 v[48:51], v11 offset:3840
    ds_read_b128 v[52:55], v11 offset:4480
    s_or_b64 exec, s[26:27], 0x41
    ds_read_b64 v[24:25], v10 offset:6144
    s_or_b64 exec, -1, 0x41
    v_mfma_f32_32x32x16_bf16 v[96:111], v[44:47], v[36:39], v[96:111]
    v_exp_f32_e64 v80, v80
    v_exp_f32 v81, v81
    v_exp_f32 v82, v82
    v_exp_f32 v83, v83
    s_waitcnt lgkmcnt(3)
    v_mfma_f32_32x32x16_bf16 v[64:79], v[20:23], v[12:15], 0
    ds_read_b128 v[20:23], v9 offset:7680
    v_exp_f32_e64 v84, v84
    v_exp_f32 v85, v85
    v_exp_f32 v86, v86
    v_exp_f32 v87, v87
    s_waitcnt lgkmcnt(1)
    v_cvt_pk_bf16_f32 v32, v80, v81
    v_cvt_pk_bf16_f32 v33, v82, v83
    v_mfma_f32_32x32x8_bf16 v[64:79], v[24:25], v[16:17], v[64:79]
    v_cvt_pk_bf16_f32 v34, v84, v85
    v_cvt_pk_bf16_f32 v35, v86, v87
    v_exp_f32 v88, v88
    v_exp_f32 v89, v89
    v_exp_f32 v90, v90
    v_exp_f32 v91, v91
    v_mfma_f32_32x32x16_bf16 v[96:111], v[48:51], v[32:35], v[96:111]
    v_exp_f32 v92, v92
    v_exp_f32 v93, v93
    v_exp_f32 v94, v94
    v_exp_f32 v95, v95
    v_cvt_pk_bf16_f32 v36, v88, v89
    v_cvt_pk_bf16_f32 v37, v90, v91
    v_cvt_pk_bf16_f32 v38, v92, v93
    v_cvt_pk_bf16_f32 v39, v94, v95
    s_or_b64 exec, s[20:21], 0x41
    ds_read_b128 v[40:43], v11 offset:6400
    ds_read_b128 v[44:47], v11 offset:7040
    s_or_b64 exec, s[26:27], 0x41
    ds_read_b64 v[24:25], v10 offset:8704
    s_or_b64 exec, -1, 0x41
    v_mfma_f32_32x32x16_bf16 v[96:111], v[52:55], v[36:39], v[96:111]
    v_exp_f32_e64 v64, v64
    v_exp_f32 v65, v65
    v_exp_f32 v66, v66
    v_exp_f32 v67, v67
    s_waitcnt lgkmcnt(3)
    v_mfma_f32_32x32x16_bf16 v[80:95], v[20:23], v[12:15], 0
    ds_read_b128 v[20:23], v9 offset:10240
    v_exp_f32_e64 v68, v68
    v_exp_f32 v69, v69
    v_exp_f32 v70, v70
    v_exp_f32 v71, v71
    s_waitcnt lgkmcnt(1)
    v_cvt_pk_bf16_f32 v32, v64, v65
    v_cvt_pk_bf16_f32 v33, v66, v67
    v_mfma_f32_32x32x8_bf16 v[80:95], v[24:25], v[16:17], v[80:95]
    v_cvt_pk_bf16_f32 v34, v68, v69
    v_cvt_pk_bf16_f32 v35, v70, v71
    v_exp_f32 v72, v72
    v_exp_f32 v73, v73
    v_exp_f32 v74, v74
    v_exp_f32 v75, v75
    v_mfma_f32_32x32x16_bf16 v[96:111], v[40:43], v[32:35], v[96:111]
    v_exp_f32 v76, v76
    v_exp_f32 v77, v77
    v_exp_f32 v78, v78
    v_exp_f32 v79, v79
    v_cvt_pk_bf16_f32 v36, v72, v73
    v_cvt_pk_bf16_f32 v37, v74, v75
    v_cvt_pk_bf16_f32 v38, v76, v77
    v_cvt_pk_bf16_f32 v39, v78, v79
    s_or_b64 exec, s[20:21], 0x41
    ds_read_b128 v[48:51], v11 offset:8960
    ds_read_b128 v[52:55], v11 offset:9600
    s_or_b64 exec, s[26:27], 0x41
    ds_read_b64 v[24:25], v10 offset:11264
    s_or_b64 exec, -1, 0x41
    v_mfma_f32_32x32x16_bf16 v[96:111], v[44:47], v[36:39], v[96:111]
    v_exp_f32_e64 v80, v80
    v_exp_f32 v81, v81
    v_exp_f32 v82, v82
    v_exp_f32 v83, v83
    s_waitcnt lgkmcnt(3)
    v_mfma_f32_32x32x16_bf16 v[64:79], v[20:23], v[12:15], 0
    ds_read_b128 v[20:23], v9 offset:12800
    v_exp_f32_e64 v84, v84
    v_exp_f32 v85, v85
    v_exp_f32 v86, v86
    v_exp_f32 v87, v87
    s_waitcnt lgkmcnt(1)
    v_cvt_pk_bf16_f32 v32, v80, v81
    v_cvt_pk_bf16_f32 v33, v82, v83
    v_mfma_f32_32x32x8_bf16 v[64:79], v[24:25], v[16:17], v[64:79]
    v_cvt_pk_bf16_f32 v34, v84, v85
    v_cvt_pk_bf16_f32 v35, v86, v87
    v_exp_f32 v88, v88
    v_exp_f32 v89, v89
    v_exp_f32 v90, v90
    v_exp_f32 v91, v91
    v_mfma_f32_32x32x16_bf16 v[96:111], v[48:51], v[32:35], v[96:111]
    v_exp_f32 v92, v92
    v_exp_f32 v93, v93
    v_exp_f32 v94, v94
    v_exp_f32 v95, v95
    v_cvt_pk_bf16_f32 v36, v88, v89
    v_cvt_pk_bf16_f32 v37, v90, v91
    v_cvt_pk_bf16_f32 v38, v92, v93
    v_cvt_pk_bf16_f32 v39, v94, v95
    s_or_b64 exec, s[20:21], 0x41
    ds_read_b128 v[40:43], v11 offset:11520
    ds_read_b128 v[44:47], v11 offset:12160
    s_or_b64 exec, s[26:27], 0x41
    ds_read_b64 v[24:25], v10 offset:13824
    s_or_b64 exec, -1, 0x41
    v_add_u32 v9, 10240, v9
    v_add_u32 v10, 10240, v10
    v_add_u32 v11, 10240, v11
    s_add_u32 s18, s18, 1
    s_bitcmp1_b32 s42, s18
    v_mfma_f32_32x32x16_bf16 v[96:111], v[52:55], v[36:39], v[96:111]
    s_cbranch_scc0 sequential_preLN__grouped_kv_mqa__dense_activation_silu__prompt_kernel_loop
    s_cmp_ge_u32 s18, 16
    s_cbranch_scc1 sequential_preLN__grouped_kv_mqa__dense_activation_silu__prompt_kernel_done
    s_cmp_gt_u32 s18, 3
    s_cbranch_scc1 sequential_preLN__grouped_kv_mqa__dense_activation_silu__prompt_kernel_psw
    s_barrier
    s_branch sequential_preLN__grouped_kv_mqa__dense_activation_silu__prompt_kernel_loop
sequential_preLN__grouped_kv_mqa__dense_activation_silu__prompt_kernel_psw:
    s_setprio 0
    s_branch sequential_preLN__grouped_kv_mqa__dense_activation_silu__prompt_kernel_loop
sequential_preLN__grouped_kv_mqa__dense_activation_silu__prompt_kernel_done:
    s_waitcnt lgkmcnt(0)
    s_nop 7
    s_nop 4
    v_mov_b32 v2, v104
    v_mov_b32 v3, v104
    v_mov_b32 v4, 0x1f800000
    s_nop 0
    v_permlane32_swap_b32 v2, v3
    s_cmp_eq_u32 s19, 1
    s_cbranch_scc1 sequential_preLN__grouped_kv_mqa__dense_activation_silu__prompt_kernel_norm
    v_cmp_nge_f32 vcc, v3, v4
    s_nop 4
    s_cmp_eq_u64 vcc, 0
    s_cbranch_scc1 sequential_preLN__grouped_kv_mqa__dense_activation_silu__prompt_kernel_norm
    v_mov_b32 v9, v6
    v_lshlrev_b32 v10, 3, v8
    s_mov_b32 exec_lo, 0
    v_mov_b32 v16, 0
    v_mov_b32 v17, 0
    s_mov_b32 exec_lo, -1
    v_mov_b32 v2, 0xff800000
    s_mov_b32 s15, 64
sequential_preLN__grouped_kv_mqa__dense_activation_silu__prompt_kernel_mx:
    ds_read_b128 v[20:23], v9
    s_mov_b64 exec, s[26:27]
    ds_read_b64 v[24:25], v10 offset:1024
    s_mov_b64 exec, -1
    v_add_u32 v9, 2560, v9
    v_add_u32 v10, 2560, v10
    s_waitcnt lgkmcnt(0)
    v_mfma_f32_32x32x16_bf16 v[64:79], v[20:23], v[12:15], 0
    v_mfma_f32_32x32x8_bf16 v[64:79], v[24:25], v[16:17], v[64:79]
    s_nop 7
    s_nop 7
    v_max3_f32 v2, v64, v65, v2
    v_max3_f32 v2, v66, v67, v2
    v_max3_f32 v2, v68, v69, v2
    v_max3_f32 v2, v70, v71, v2
    v_max3_f32 v2, v72, v73, v2
    v_max3_f32 v2, v74, v75, v2
    v_max3_f32 v2, v76, v77, v2
    v_max3_f32 v2, v78, v79, v2
    s_sub_u32 s15, s15, 1
    s_cmp_lg_u32 s15, 0
    s_cbranch_scc1 sequential_preLN__grouped_kv_mqa__dense_activation_silu__prompt_kernel_mx
    v_mov_b32 v3, v2
    s_nop 1
    v_permlane32_swap_b32 v2, v3
    s_nop 1
    v_max_f32 v2, v2, v3
    v_sub_f32 v2, 0, v2
    s_mov_b32 s19, 1
    s_mov_b32 s18, 0
    s_mov_b32 s42, 0x10000
    s_branch sequential_preLN__grouped_kv_mqa__dense_activation_silu__prompt_kernel_start
sequential_preLN__grouped_kv_mqa__dense_activation_silu__prompt_kernel_norm:
    s_nop 1
    v_rcp_f32 v3, v3
    s_lshr_b32 s15, s3, 1
    s_mul_i32 s15, s15, 5
    v_add_u32 v2, s15, v7
    v_lshrrev_b32 v4, 1, v2
    v_lshlrev_b32 v4, 8, v4
    v_and_b32 v2, 1, v2
    v_lshl_add_u32 v4, v2, 3, v4
    v_and_b32 v2, 15, v1
    v_lshl_add_u32 v4, v2, 4, v4
    v_bfe_u32 v2, v1, 4, 1
    v_mul_u32_u24 v2, 2560, v2
    s_and_b32 s15, s3, 1
    s_mul_i32 s15, s15, 5120
    s_add_u32 s15, s15, 143360
    v_add3_u32 v4, v4, v2, s15
    v_mul_f32 v96, v96, v3
    v_mul_f32 v97, v97, v3
    v_mul_f32 v98, v98, v3
    v_mul_f32 v99, v99, v3
    v_mul_f32 v100, v100, v3
    v_mul_f32 v101, v101, v3
    v_mul_f32 v102, v102, v3
    v_mul_f32 v103, v103, v3
    v_mul_f32 v104, v104, v3
    v_mul_f32 v105, v105, v3
    v_mul_f32 v106, v106, v3
    v_mul_f32 v107, v107, v3
    v_cvt_pk_bf16_f32 v32, v96, v97
    v_cvt_pk_bf16_f32 v33, v98, v99
    v_cvt_pk_bf16_f32 v34, v100, v101
    v_cvt_pk_bf16_f32 v35, v102, v103
    v_cvt_pk_bf16_f32 v36, v104, v105
    v_cvt_pk_bf16_f32 v37, v106, v107
    s_setprio 0
    s_lshl_b32 s16, s12, 2
    s_lshr_b32 s15, s3, 1
    s_add_u32 s16, s16, s15
    s_mul_i32 s25, s16, 20480
    s_mul_i32 s16, s13, 2560
    s_add_u32 s25, s25, s16
    s_and_b32 s16, s3, 1
    s_mul_i32 s16, s16, 1280
    s_add_u32 s25, s25, s16
    s_add_u32 s25, s25, 3145728
    s_mul_i32 s15, s15, 2560
    s_add_u32 s15, s15, s16
    s_add_u32 s15, s15, 143360
    v_add_u32 v2, s15, v6
    s_barrier
    ds_write_b64 v4, v[32:33] offset:0
    ds_write_b64 v4, v[34:35] offset:256
    s_mov_b32 exec_hi, 0
    ds_write_b64 v4, v[36:37] offset:512
    s_mov_b64 exec, -1
    s_waitcnt lgkmcnt(0)
    s_barrier
    ds_read_b128 v[32:35], v2
    ds_read_b128 v[36:39], v2 offset:1024
    s_waitcnt lgkmcnt(1)
    buffer_store_dwordx4 v[32:35], v6, s[4:7], s25 offen sc1
    s_mov_b64 exec, 0xffff
    s_waitcnt lgkmcnt(0)
    buffer_store_dwordx4 v[36:39], v6, s[4:7], s25 offen offset:1024 sc1
    s_mov_b64 exec, -1
    s_lshr_b32 s41, s61, 3
    s_lshl_b32 s40, s60, 2
    s_add_u32 s12, s41, s40
    s_and_b32 s13, s61, 7
    s_mul_i32 s14, s41, 5
    s_lshr_b32 s14, s14, 1
    s_add_u32 s14, s14, s13
    s_cmp_ge_u32 s14, 10
    s_cselect_b32 s38, 10, 0
    s_sub_u32 s14, s14, s38
    s_lshr_b32 s39, s61, 4
    s_lshl_b32 s15, s60, 1
    s_add_u32 s15, s15, s39
    s_and_b32 s16, s61, 15
    s_mul_i32 s17, s16, 5
    s_lshr_b32 s17, s17, 3
    s_mul_i32 s39, s39, 5
    s_add_u32 s17, s17, s39
    s_cmp_ge_u32 s17, 10
    s_cselect_b32 s38, 10, 0
    s_sub_u32 s17, s17, s38
    s_mov_b32 s18, s12
    s_mov_b32 s19, s13
    s_mul_i32 s20, s41, 7
    s_mul_i32 s41, s19, 3
    s_add_u32 s20, s20, s41
    s_cmp_ge_u32 s20, 27
    s_cselect_b32 s39, 27, 0
    s_sub_u32 s20, s20, s39
    s_cmp_lt_u32 s3, 4
    s_cbranch_scc1 sequential_preLN__grouped_kv_mqa__dense_activation_silu__prompt_kernel_comp
    s_mul_i32 s38, s62, 2560
    v_add_u32 v24, s38, v6
    s_mul_i32 s38, s62, 3584
    v_add_u32 v25, s38, v6
    v_add_u32 v26, 18432, v6
    v_lshlrev_b32 v27, 11, v1
    v_mov_b32 v28, s100
    v_lshrrev_b32 v9, 4, v1
    s_setprio 2
    s_mul_i32 s26, s13, 10
    s_add_u32 s26, s26, s14
    s_mul_i32 s26, s26, 10240
    s_add_u32 s26, s26, 15728640
    s_mov_b32 s27, s14
    s_mul_i32 s30, s62, 2560
    s_lshl_b32 s38, s12, 2
    s_add_u32 s38, s38, s62
    s_mul_i32 s28, s38, 20480
    s_lshl_b32 s38, s14, 11
    s_add_u32 s28, s28, s38
    s_add_u32 s28, s28, 3145728
    s_mov_b32 s29, s14
    s_mul_i32 s31, s62, 2048
    s_lshl_b32 s32, s12, 14
    s_lshl_b32 s38, s13, 7
    s_waitcnt vmcnt(0)
    s_add_u32 s32, s32, s38
    s_add_u32 s32, s32, 22020096
    s_lshl_b32 s41, s12, 3
    s_add_u32 s41, s41, s13
    s_lshl_b32 s41, s41, 11
    s_add_u32 s41, s41, 22020096
    s_barrier
    s_cmp_lg_u32 s3, 4
    s_cbranch_scc1 sequential_preLN__grouped_kv_mqa__dense_activation_silu__prompt_kernel_nqC
    s_mov_b64 exec, 255
    buffer_store_dword v28, v27, s[4:7], s32 offen sc1
    s_mov_b64 exec, -1
sequential_preLN__grouped_kv_mqa__dense_activation_silu__prompt_kernel_nqC:
    s_add_u32 m0, s30, 0
    s_add_u32 s27, s27, 1
    buffer_load_dwordx4 v24, s[4:7], s26 offen offset:0 sc1 lds
    buffer_load_dwordx4 v24, s[4:7], s26 offen offset:1024 sc1 lds
    s_mov_b32 exec_hi, 0
    buffer_load_dwordx4 v24, s[4:7], s26 offen offset:2048 sc1 lds
    s_mov_b32 exec_hi, -1
    s_cmp_eq_u32 s27, 10
    s_cselect_b32 s38, -92160, 0
    s_cselect_b32 s27, 0, s27
    s_cselect_b32 s38, s38, 10240
    s_add_u32 s26, s26, s38
    s_add_u32 m0, s30, 10240
    s_add_u32 s27, s27, 1
    buffer_load_dwordx4 v24, s[4:7], s26 offen offset:0 sc1 lds
    buffer_load_dwordx4 v24, s[4:7], s26 offen offset:1024 sc1 lds
    s_mov_b32 exec_hi, 0
    buffer_load_dwordx4 v24, s[4:7], s26 offen offset:2048 sc1 lds
    s_mov_b32 exec_hi, -1
    s_cmp_eq_u32 s27, 10
    s_cselect_b32 s38, -92160, 0
    s_cselect_b32 s27, 0, s27
    s_cselect_b32 s38, s38, 10240
    s_add_u32 s26, s26, s38
    s_add_u32 m0, s30, 20480
    s_add_u32 s27, s27, 1
    buffer_load_dwordx4 v24, s[4:7], s26 offen offset:0 sc1 lds
    buffer_load_dwordx4 v24, s[4:7], s26 offen offset:1024 sc1 lds
    s_mov_b32 exec_hi, 0
    buffer_load_dwordx4 v24, s[4:7], s26 offen offset:2048 sc1 lds
    s_mov_b32 exec_hi, -1
    s_cmp_eq_u32 s27, 10
    s_cselect_b32 s38, -92160, 0
    s_cselect_b32 s27, 0, s27
    s_cselect_b32 s38, s38, 10240
    s_add_u32 s26, s26, s38
    s_add_u32 m0, s30, 30720
    s_add_u32 s27, s27, 1
    buffer_load_dwordx4 v24, s[4:7], s26 offen offset:0 sc1 lds
    buffer_load_dwordx4 v24, s[4:7], s26 offen offset:1024 sc1 lds
    s_mov_b32 exec_hi, 0
    buffer_load_dwordx4 v24, s[4:7], s26 offen offset:2048 sc1 lds
    s_mov_b32 exec_hi, -1
    s_cmp_eq_u32 s27, 10
    s_cselect_b32 s38, -92160, 0
    s_cselect_b32 s27, 0, s27
    s_cselect_b32 s38, s38, 10240
    s_add_u32 s26, s26, s38
    s_add_u32 m0, s30, 40960
    s_add_u32 s27, s27, 1
    buffer_load_dwordx4 v24, s[4:7], s26 offen offset:0 sc1 lds
    buffer_load_dwordx4 v24, s[4:7], s26 offen offset:1024 sc1 lds
    s_mov_b32 exec_hi, 0
    buffer_load_dwordx4 v24, s[4:7], s26 offen offset:2048 sc1 lds
    s_mov_b32 exec_hi, -1
    s_cmp_eq_u32 s27, 10
    s_cselect_b32 s38, -92160, 0
    s_cselect_b32 s27, 0, s27
    s_cselect_b32 s38, s38, 10240
    s_add_u32 s26, s26, s38
    s_add_u32 m0, s30, 51200
    s_add_u32 s27, s27, 1
    buffer_load_dwordx4 v24, s[4:7], s26 offen offset:0 sc1 lds
    buffer_load_dwordx4 v24, s[4:7], s26 offen offset:1024 sc1 lds
    s_mov_b32 exec_hi, 0
    buffer_load_dwordx4 v24, s[4:7], s26 offen offset:2048 sc1 lds
    s_mov_b32 exec_hi, -1
    s_cmp_eq_u32 s27, 10
    s_cselect_b32 s38, -92160, 0
    s_cselect_b32 s27, 0, s27
    s_cselect_b32 s38, s38, 10240
    s_add_u32 s26, s26, s38
    s_add_u32 m0, s30, 61440
    s_add_u32 s27, s27, 1
    buffer_load_dwordx4 v24, s[4:7], s26 offen offset:0 sc1 lds
    buffer_load_dwordx4 v24, s[4:7], s26 offen offset:1024 sc1 lds
    s_mov_b32 exec_hi, 0
    buffer_load_dwordx4 v24, s[4:7], s26 offen offset:2048 sc1 lds
    s_mov_b32 exec_hi, -1
    s_cmp_eq_u32 s27, 10
    s_cselect_b32 s38, -92160, 0
    s_cselect_b32 s27, 0, s27
    s_cselect_b32 s38, s38, 10240
    s_add_u32 s26, s26, s38
    s_add_u32 m0, s30, 71680
    s_add_u32 s27, s27, 1
    buffer_load_dwordx4 v24, s[4:7], s26 offen offset:0 sc1 lds
    buffer_load_dwordx4 v24, s[4:7], s26 offen offset:1024 sc1 lds
    s_mov_b32 exec_hi, 0
    buffer_load_dwordx4 v24, s[4:7], s26 offen offset:2048 sc1 lds
    s_mov_b32 exec_hi, -1
    s_cmp_eq_u32 s27, 10
    s_cselect_b32 s38, -92160, 0
    s_cselect_b32 s27, 0, s27
    s_cselect_b32 s38, s38, 10240
    s_add_u32 s26, s26, s38
    s_add_u32 m0, s30, 81920
    s_add_u32 s27, s27, 1
    buffer_load_dwordx4 v24, s[4:7], s26 offen offset:0 sc1 lds
    buffer_load_dwordx4 v24, s[4:7], s26 offen offset:1024 sc1 lds
    s_mov_b32 exec_hi, 0
    buffer_load_dwordx4 v24, s[4:7], s26 offen offset:2048 sc1 lds
    s_mov_b32 exec_hi, -1
    s_cmp_eq_u32 s27, 10
    s_cselect_b32 s38, -92160, 0
    s_cselect_b32 s27, 0, s27
    s_cselect_b32 s38, s38, 10240
    s_add_u32 s26, s26, s38
    s_add_u32 m0, s30, 92160
    s_add_u32 s27, s27, 1
    buffer_load_dwordx4 v24, s[4:7], s26 offen offset:0 sc1 lds
    buffer_load_dwordx4 v24, s[4:7], s26 offen offset:1024 sc1 lds
    s_mov_b32 exec_hi, 0
    buffer_load_dwordx4 v24, s[4:7], s26 offen offset:2048 sc1 lds
    s_mov_b32 exec_hi, -1
    s_cmp_eq_u32 s27, 10
    s_cselect_b32 s38, -92160, 0
    s_cselect_b32 s27, 0, s27
    s_cselect_b32 s38, s38, 10240
    s_add_u32 s26, s26, s38
    s_cmp_lg_u32 s3, 4
    s_cbranch_scc1 sequential_preLN__grouped_kv_mqa__dense_activation_silu__prompt_kernel_npC
    s_mov_b32 s39, 524288
    v_lshlrev_b32 v21, 7, v1
    s_mov_b64 exec, 255
sequential_preLN__grouped_kv_mqa__dense_activation_silu__prompt_kernel_pollC:
    buffer_load_dword v20, v21, s[4:7], s41 offen sc1
sequential_preLN__grouped_kv_mqa__dense_activation_silu__prompt_kernel_pollwC:
    s_waitcnt vmcnt(0)
    v_xor_b32 v22, s100, v20
    v_cmp_ne_u32 vcc, 0, v22
    s_sub_u32 s39, s39, 1
    s_cbranch_scc1 sequential_preLN__grouped_kv_mqa__dense_activation_silu__prompt_kernel_pollxC
    s_nop 1
    s_cmp_eq_u64 vcc, 0
    s_cbranch_scc1 sequential_preLN__grouped_kv_mqa__dense_activation_silu__prompt_kernel_pollxC
    s_sleep 2
    s_branch sequential_preLN__grouped_kv_mqa__dense_activation_silu__prompt_kernel_pollC
sequential_preLN__grouped_kv_mqa__dense_activation_silu__prompt_kernel_pollxC:
    s_mov_b64 exec, -1
sequential_preLN__grouped_kv_mqa__dense_activation_silu__prompt_kernel_npC:
    s_barrier
    s_add_u32 m0, s31, 102400
    s_add_u32 s29, s29, 1
    buffer_load_dwordx4 v6, s[4:7], s28 offen offset:0 sc1 lds
    buffer_load_dwordx4 v6, s[4:7], s28 offen offset:1024 sc1 lds
    s_cmp_eq_u32 s29, 10
    s_cselect_b32 s38, -18432, 0
    s_cselect_b32 s29, 0, s29
    s_cselect_b32 s38, s38, 2048
    s_add_u32 s28, s28, s38
    s_add_u32 m0, s31, 110592
    s_add_u32 s29, s29, 1
    buffer_load_dwordx4 v6, s[4:7], s28 offen offset:0 sc1 lds
    buffer_load_dwordx4 v6, s[4:7], s28 offen offset:1024 sc1 lds
    s_cmp_eq_u32 s29, 10
    s_cselect_b32 s38, -18432, 0
    s_cselect_b32 s29, 0, s29
    s_cselect_b32 s38, s38, 2048
    s_add_u32 s28, s28, s38
    s_add_u32 m0, s31, 118784
    s_add_u32 s29, s29, 1
    buffer_load_dwordx4 v6, s[4:7], s28 offen offset:0 sc1 lds
    buffer_load_dwordx4 v6, s[4:7], s28 offen offset:1024 sc1 lds
    s_cmp_eq_u32 s29, 10
    s_cselect_b32 s38, -18432, 0
    s_cselect_b32 s29, 0, s29
    s_cselect_b32 s38, s38, 2048
    s_add_u32 s28, s28, s38
    s_add_u32 m0, s31, 126976
    s_add_u32 s29, s29, 1
    buffer_load_dwordx4 v6, s[4:7], s28 offen offset:0 sc1 lds
    buffer_load_dwordx4 v6, s[4:7], s28 offen offset:1024 sc1 lds
    s_cmp_eq_u32 s29, 10
    s_cselect_b32 s38, -18432, 0
    s_cselect_b32 s29, 0, s29
    s_cselect_b32 s38, s38, 2048
    s_add_u32 s28, s28, s38
    s_add_u32 m0, s31, 135168
    s_add_u32 s29, s29, 1
    buffer_load_dwordx4 v6, s[4:7], s28 offen offset:0 sc1 lds
    buffer_load_dwordx4 v6, s[4:7], s28 offen offset:1024 sc1 lds
    s_cmp_eq_u32 s29, 10
    s_cselect_b32 s38, -18432, 0
    s_cselect_b32 s29, 0, s29
    s_cselect_b32 s38, s38, 2048
    s_add_u32 s28, s28, s38
    s_waitcnt vmcnt(8)
    s_barrier
    s_waitcnt vmcnt(6)
    s_barrier
    s_add_u32 m0, s31, 102400
    s_add_u32 s29, s29, 1
    buffer_load_dwordx4 v6, s[4:7], s28 offen offset:0 sc1 lds
    buffer_load_dwordx4 v6, s[4:7], s28 offen offset:1024 sc1 lds
    s_cmp_eq_u32 s29, 10
    s_cselect_b32 s38, -18432, 0
    s_cselect_b32 s29, 0, s29
    s_cselect_b32 s38, s38, 2048
    s_add_u32 s28, s28, s38
    s_waitcnt vmcnt(6)
    s_barrier
    s_add_u32 m0, s31, 110592
    s_add_u32 s29, s29, 1
    buffer_load_dwordx4 v6, s[4:7], s28 offen offset:0 sc1 lds
    buffer_load_dwordx4 v6, s[4:7], s28 offen offset:1024 sc1 lds
    s_cmp_eq_u32 s29, 10
    s_cselect_b32 s38, -18432, 0
    s_cselect_b32 s29, 0, s29
    s_cselect_b32 s38, s38, 2048
    s_add_u32 s28, s28, s38
    s_waitcnt vmcnt(6)
    s_barrier
    s_add_u32 m0, s31, 118784
    s_add_u32 s29, s29, 1
    buffer_load_dwordx4 v6, s[4:7], s28 offen offset:0 sc1 lds
    buffer_load_dwordx4 v6, s[4:7], s28 offen offset:1024 sc1 lds
    s_cmp_eq_u32 s29, 10
    s_cselect_b32 s38, -18432, 0
    s_cselect_b32 s29, 0, s29
    s_cselect_b32 s38, s38, 2048
    s_add_u32 s28, s28, s38
    s_waitcnt vmcnt(6)
    s_barrier
    s_add_u32 m0, s31, 126976
    s_add_u32 s29, s29, 1
    buffer_load_dwordx4 v6, s[4:7], s28 offen offset:0 sc1 lds
    buffer_load_dwordx4 v6, s[4:7], s28 offen offset:1024 sc1 lds
    s_cmp_eq_u32 s29, 10
    s_cselect_b32 s38, -18432, 0
    s_cselect_b32 s29, 0, s29
    s_cselect_b32 s38, s38, 2048
    s_add_u32 s28, s28, s38
    s_waitcnt vmcnt(6)
    s_barrier
    s_add_u32 m0, s31, 135168
    s_add_u32 s29, s29, 1
    buffer_load_dwordx4 v6, s[4:7], s28 offen offset:0 sc1 lds
    buffer_load_dwordx4 v6, s[4:7], s28 offen offset:1024 sc1 lds
    s_cmp_eq_u32 s29, 10
    s_cselect_b32 s38, -18432, 0
    s_cselect_b32 s29, 0, s29
    s_cselect_b32 s38, s38, 2048
    s_add_u32 s28, s28, s38
    s_mul_i32 s26, s16, 10
    s_add_u32 s26, s26, s17
    s_mul_i32 s26, s26, 14336
    s_add_u32 s26, s26, 16777216
    s_mov_b32 s27, s17
    s_mul_i32 s30, s62, 3584
    s_add_u32 m0, s30, 28672
    s_add_u32 s27, s27, 1
    buffer_load_dwordx4 v25, s[4:7], s26 offen offset:0 sc1 lds
    buffer_load_dwordx4 v25, s[4:7], s26 offen offset:1024 sc1 lds
    buffer_load_dwordx4 v25, s[4:7], s26 offen offset:2048 sc1 lds
    s_mov_b32 exec_hi, 0
    buffer_load_dwordx4 v25, s[4:7], s26 offen offset:3072 sc1 lds
    s_mov_b32 exec_hi, -1
    s_cmp_eq_u32 s27, 10
    s_cselect_b32 s38, -129024, 0
    s_cselect_b32 s27, 0, s27
    s_cselect_b32 s38, s38, 14336
    s_add_u32 s26, s26, s38
    s_waitcnt vmcnt(10)
    s_barrier
    s_add_u32 m0, s30, 43008
    s_add_u32 s27, s27, 1
    buffer_load_dwordx4 v25, s[4:7], s26 offen offset:0 sc1 lds
    buffer_load_dwordx4 v25, s[4:7], s26 offen offset:1024 sc1 lds
    buffer_load_dwordx4 v25, s[4:7], s26 offen offset:2048 sc1 lds
    s_mov_b32 exec_hi, 0
    buffer_load_dwordx4 v25, s[4:7], s26 offen offset:3072 sc1 lds
    s_mov_b32 exec_hi, -1
    s_cmp_eq_u32 s27, 10
    s_cselect_b32 s38, -129024, 0
    s_cselect_b32 s27, 0, s27
    s_cselect_b32 s38, s38, 14336
    s_add_u32 s26, s26, s38
    s_waitcnt vmcnt(12)
    s_barrier
    s_add_u32 m0, s30, 57344
    s_add_u32 s27, s27, 1
    buffer_load_dwordx4 v25, s[4:7], s26 offen offset:0 sc1 lds
    buffer_load_dwordx4 v25, s[4:7], s26 offen offset:1024 sc1 lds
    buffer_load_dwordx4 v25, s[4:7], s26 offen offset:2048 sc1 lds
    s_mov_b32 exec_hi, 0
    buffer_load_dwordx4 v25, s[4:7], s26 offen offset:3072 sc1 lds
    s_mov_b32 exec_hi, -1
    s_cmp_eq_u32 s27, 10
    s_cselect_b32 s38, -129024, 0
    s_cselect_b32 s27, 0, s27
    s_cselect_b32 s38, s38, 14336
    s_add_u32 s26, s26, s38
    s_waitcnt vmcnt(14)
    s_barrier
    s_waitcnt vmcnt(12)
    s_barrier
    s_barrier
    s_lshl_b32 s38, s15, 2
    s_add_u32 s38, s38, s62
    s_mul_i32 s28, s38, 40960
    s_lshl_b32 s38, s17, 11
    s_add_u32 s28, s28, s38
    s_add_u32 s28, s28, 5767168
    s_mov_b32 s29, s17
    s_mul_i32 s31, s62, 4096
    s_lshr_b32 s32, s12, 1
    s_lshl_b32 s32, s32, 15
    s_and_b32 s38, s12, 1
    s_lshl_b32 s38, s38, 3
    s_add_u32 s38, s38, s13
    s_lshl_b32 s38, s38, 7
    s_add_u32 s32, s32, s38
    s_add_u32 s32, s32, 22544384
    s_lshl_b32 s41, s15, 4
    s_add_u32 s41, s41, s16
    s_lshl_b32 s41, s41, 11
    s_add_u32 s41, s41, 22544384
    s_lshl_b32 s45, s15, 2
    s_add_u32 s45, s45, s62
    s_lshl_b32 s45, s45, 1
    s_add_u32 s45, s45, 1
    s_mul_i32 s42, s16, 7
    s_sub_i32 s40, s16, 12
    s_max_i32 s40, s40, 0
    s_sub_u32 s42, s42, s40
    s_cmp_ge_u32 s16, 12
    s_cselect_b32 s43, 6, 7
    s_lshl_b32 s38, s42, 9
    s_mul_i32 s46, s45, 55296
    s_add_u32 s46, s46, s38
    s_add_u32 s46, s46, 8388608
    s_cmp_lg_u32 s3, 5
    s_cbranch_scc1 sequential_preLN__grouped_kv_mqa__dense_activation_silu__prompt_kernel_ncs
    s_lshl_b32 s38, s42, 6
    s_add_u32 s38, s38, 1048576
    buffer_load_dwordx4 v[40:43], v6, s[4:7], s38 offen sc1
    s_add_u32 s38, s38, 7168
    buffer_load_dwordx4 v[44:47], v6, s[4:7], s38 offen sc1
    s_add_u32 s38, s38, 7168
    buffer_load_dwordx4 v[48:51], v6, s[4:7], s38 offen sc1
    s_add_u32 s38, s38, 7168
    buffer_load_dwordx4 v[52:55], v6, s[4:7], s38 offen sc1
    s_add_u32 s38, s38, 7168
    buffer_load_dwordx4 v[56:59], v6, s[4:7], s38 offen sc1
    s_add_u32 s38, s38, 7168
    buffer_load_dwordx4 v[60:63], v6, s[4:7], s38 offen sc1
    s_add_u32 s38, s38, 7168
    buffer_load_dwordx4 v[64:67], v6, s[4:7], s38 offen sc1
    s_add_u32 s38, s38, 7168
    buffer_load_dwordx4 v[68:71], v6, s[4:7], s38 offen sc1
    s_add_u32 s38, s38, 7168
    buffer_load_dwordx4 v[72:75], v6, s[4:7], s38 offen sc1
    s_add_u32 s38, s38, 7168
    buffer_load_dwordx4 v[76:79], v6, s[4:7], s38 offen sc1
    s_add_u32 s38, s38, 7168
    buffer_load_dwordx4 v[80:83], v6, s[4:7], s38 offen sc1
    s_add_u32 s38, s38, 7168
    buffer_load_dwordx4 v[84:87], v6, s[4:7], s38 offen sc1
    s_add_u32 s38, s38, 7168
    buffer_load_dwordx4 v[88:91], v6, s[4:7], s38 offen sc1
    s_add_u32 s38, s38, 7168
    buffer_load_dwordx4 v[92:95], v6, s[4:7], s38 offen sc1
    s_add_u32 s38, s38, 7168
    buffer_load_dwordx4 v[96:99], v6, s[4:7], s38 offen sc1
    s_add_u32 s38, s38, 7168
    buffer_load_dwordx4 v[100:103], v6, s[4:7], s38 offen sc1
    s_add_u32 s38, s38, 7168
    buffer_load_dwordx4 v[104:107], v6, s[4:7], s38 offen sc1
    s_add_u32 s38, s38, 7168
    buffer_load_dwordx4 v[108:111], v6, s[4:7], s38 offen sc1
    s_add_u32 s38, s38, 7168
    buffer_load_dwordx4 v[112:115], v6, s[4:7], s38 offen sc1
    s_add_u32 s38, s38, 7168
    buffer_load_dwordx4 v[116:119], v6, s[4:7], s38 offen sc1
    s_add_u32 s38, s38, 7168
    v_add_u32 v2, 153600, v6
    s_waitcnt vmcnt(18)
    v_pk_add_f32 v[40:41], v[40:41], v[44:45]
    v_pk_add_f32 v[42:43], v[42:43], v[46:47]
    s_waitcnt vmcnt(17)
    v_pk_add_f32 v[40:41], v[40:41], v[48:49]
    v_pk_add_f32 v[42:43], v[42:43], v[50:51]
    s_waitcnt vmcnt(16)
    v_pk_add_f32 v[40:41], v[40:41], v[52:53]
    v_pk_add_f32 v[42:43], v[42:43], v[54:55]
    s_waitcnt vmcnt(15)
    v_pk_add_f32 v[40:41], v[40:41], v[56:57]
    v_pk_add_f32 v[42:43], v[42:43], v[58:59]
    s_waitcnt vmcnt(14)
    v_pk_add_f32 v[40:41], v[40:41], v[60:61]
    v_pk_add_f32 v[42:43], v[42:43], v[62:63]
    s_waitcnt vmcnt(13)
    v_pk_add_f32 v[40:41], v[40:41], v[64:65]
    v_pk_add_f32 v[42:43], v[42:43], v[66:67]
    s_waitcnt vmcnt(12)
    v_pk_add_f32 v[40:41], v[40:41], v[68:69]
    v_pk_add_f32 v[42:43], v[42:43], v[70:71]
    s_waitcnt vmcnt(11)
    v_pk_add_f32 v[40:41], v[40:41], v[72:73]
    v_pk_add_f32 v[42:43], v[42:43], v[74:75]
    s_waitcnt vmcnt(10)
    v_pk_add_f32 v[40:41], v[40:41], v[76:77]
    v_pk_add_f32 v[42:43], v[42:43], v[78:79]
    s_waitcnt vmcnt(9)
    v_pk_add_f32 v[40:41], v[40:41], v[80:81]
    v_pk_add_f32 v[42:43], v[42:43], v[82:83]
    s_waitcnt vmcnt(8)
    v_pk_add_f32 v[40:41], v[40:41], v[84:85]
    v_pk_add_f32 v[42:43], v[42:43], v[86:87]
    s_waitcnt vmcnt(7)
    v_pk_add_f32 v[40:41], v[40:41], v[88:89]
    v_pk_add_f32 v[42:43], v[42:43], v[90:91]
    s_waitcnt vmcnt(6)
    v_pk_add_f32 v[40:41], v[40:41], v[92:93]
    v_pk_add_f32 v[42:43], v[42:43], v[94:95]
    s_waitcnt vmcnt(5)
    v_pk_add_f32 v[40:41], v[40:41], v[96:97]
    v_pk_add_f32 v[42:43], v[42:43], v[98:99]
    s_waitcnt vmcnt(4)
    v_pk_add_f32 v[40:41], v[40:41], v[100:101]
    v_pk_add_f32 v[42:43], v[42:43], v[102:103]
    s_waitcnt vmcnt(3)
    v_pk_add_f32 v[40:41], v[40:41], v[104:105]
    v_pk_add_f32 v[42:43], v[42:43], v[106:107]
    s_waitcnt vmcnt(2)
    v_pk_add_f32 v[40:41], v[40:41], v[108:109]
    v_pk_add_f32 v[42:43], v[42:43], v[110:111]
    s_waitcnt vmcnt(1)
    v_pk_add_f32 v[40:41], v[40:41], v[112:113]
    v_pk_add_f32 v[42:43], v[42:43], v[114:115]
    s_waitcnt vmcnt(0)
    v_pk_add_f32 v[40:41], v[40:41], v[116:117]
    v_pk_add_f32 v[42:43], v[42:43], v[118:119]
    s_mov_b64 exec, 0xfffffff
    ds_write_b128 v2, v[40:43]
    s_mov_b64 exec, -1
    s_waitcnt lgkmcnt(0)
sequential_preLN__grouped_kv_mqa__dense_activation_silu__prompt_kernel_ncs:
    s_barrier
    s_cmp_lg_u32 s3, 4
    s_cbranch_scc1 sequential_preLN__grouped_kv_mqa__dense_activation_silu__prompt_kernel_nqD
    s_mov_b64 exec, 65535
    buffer_store_dword v28, v27, s[4:7], s32 offen sc1
    s_mov_b64 exec, -1
sequential_preLN__grouped_kv_mqa__dense_activation_silu__prompt_kernel_nqD:
    s_add_u32 m0, s30, 71680
    s_add_u32 s27, s27, 1
    buffer_load_dwordx4 v25, s[4:7], s26 offen offset:0 sc1 lds
    buffer_load_dwordx4 v25, s[4:7], s26 offen offset:1024 sc1 lds
    buffer_load_dwordx4 v25, s[4:7], s26 offen offset:2048 sc1 lds
    s_mov_b32 exec_hi, 0
    buffer_load_dwordx4 v25, s[4:7], s26 offen offset:3072 sc1 lds
    s_mov_b32 exec_hi, -1
    s_cmp_eq_u32 s27, 10
    s_cselect_b32 s38, -129024, 0
    s_cselect_b32 s27, 0, s27
    s_cselect_b32 s38, s38, 14336
    s_add_u32 s26, s26, s38
    s_add_u32 m0, s30, 0
    s_add_u32 s27, s27, 1
    buffer_load_dwordx4 v25, s[4:7], s26 offen offset:0 sc1 lds
    buffer_load_dwordx4 v25, s[4:7], s26 offen offset:1024 sc1 lds
    buffer_load_dwordx4 v25, s[4:7], s26 offen offset:2048 sc1 lds
    s_mov_b32 exec_hi, 0
    buffer_load_dwordx4 v25, s[4:7], s26 offen offset:3072 sc1 lds
    s_mov_b32 exec_hi, -1
    s_cmp_eq_u32 s27, 10
    s_cselect_b32 s38, -129024, 0
    s_cselect_b32 s27, 0, s27
    s_cselect_b32 s38, s38, 14336
    s_add_u32 s26, s26, s38
    s_add_u32 m0, s30, 14336
    s_add_u32 s27, s27, 1
    buffer_load_dwordx4 v25, s[4:7], s26 offen offset:0 sc1 lds
    buffer_load_dwordx4 v25, s[4:7], s26 offen offset:1024 sc1 lds
    buffer_load_dwordx4 v25, s[4:7], s26 offen offset:2048 sc1 lds
    s_mov_b32 exec_hi, 0
    buffer_load_dwordx4 v25, s[4:7], s26 offen offset:3072 sc1 lds
    s_mov_b32 exec_hi, -1
    s_cmp_eq_u32 s27, 10
    s_cselect_b32 s38, -129024, 0
    s_cselect_b32 s27, 0, s27
    s_cselect_b32 s38, s38, 14336
    s_add_u32 s26, s26, s38
    s_cmp_lg_u32 s3, 4
    s_cbranch_scc1 sequential_preLN__grouped_kv_mqa__dense_activation_silu__prompt_kernel_npD
    s_mov_b32 s39, 524288
    v_lshlrev_b32 v21, 7, v1
    s_mov_b64 exec, 65535
sequential_preLN__grouped_kv_mqa__dense_activation_silu__prompt_kernel_pollD:
    buffer_load_dword v20, v21, s[4:7], s41 offen sc1
sequential_preLN__grouped_kv_mqa__dense_activation_silu__prompt_kernel_pollwD:
    s_waitcnt vmcnt(0)
    v_xor_b32 v22, s100, v20
    v_cmp_ne_u32 vcc, 0, v22
    s_sub_u32 s39, s39, 1
    s_cbranch_scc1 sequential_preLN__grouped_kv_mqa__dense_activation_silu__prompt_kernel_pollxD
    s_nop 1
    s_cmp_eq_u64 vcc, 0
    s_cbranch_scc1 sequential_preLN__grouped_kv_mqa__dense_activation_silu__prompt_kernel_pollxD
    s_sleep 2
    s_branch sequential_preLN__grouped_kv_mqa__dense_activation_silu__prompt_kernel_pollD
sequential_preLN__grouped_kv_mqa__dense_activation_silu__prompt_kernel_pollxD:
    s_mov_b64 exec, -1
sequential_preLN__grouped_kv_mqa__dense_activation_silu__prompt_kernel_npD:
    s_barrier
    s_add_u32 m0, s31, 86016
    s_add_u32 s29, s29, 1
    buffer_load_dwordx4 v6, s[4:7], s28 offen offset:0 sc1 lds
    buffer_load_dwordx4 v6, s[4:7], s28 offen offset:1024 sc1 lds
    buffer_load_dwordx4 v26, s[4:7], s28 offen offset:2048 sc1 lds
    buffer_load_dwordx4 v26, s[4:7], s28 offen offset:3072 sc1 lds
    s_cmp_eq_u32 s29, 10
    s_cselect_b32 s38, -18432, 0
    s_cselect_b32 s29, 0, s29
    s_cselect_b32 s38, s38, 2048
    s_add_u32 s28, s28, s38
    s_add_u32 m0, s31, 102400
    s_add_u32 s29, s29, 1
    buffer_load_dwordx4 v6, s[4:7], s28 offen offset:0 sc1 lds
    buffer_load_dwordx4 v6, s[4:7], s28 offen offset:1024 sc1 lds
    buffer_load_dwordx4 v26, s[4:7], s28 offen offset:2048 sc1 lds
    buffer_load_dwordx4 v26, s[4:7], s28 offen offset:3072 sc1 lds
    s_cmp_eq_u32 s29, 10
    s_cselect_b32 s38, -18432, 0
    s_cselect_b32 s29, 0, s29
    s_cselect_b32 s38, s38, 2048
    s_add_u32 s28, s28, s38
    s_add_u32 m0, s31, 118784
    s_add_u32 s29, s29, 1
    buffer_load_dwordx4 v6, s[4:7], s28 offen offset:0 sc1 lds
    buffer_load_dwordx4 v6, s[4:7], s28 offen offset:1024 sc1 lds
    buffer_load_dwordx4 v26, s[4:7], s28 offen offset:2048 sc1 lds
    buffer_load_dwordx4 v26, s[4:7], s28 offen offset:3072 sc1 lds
    s_cmp_eq_u32 s29, 10
    s_cselect_b32 s38, -18432, 0
    s_cselect_b32 s29, 0, s29
    s_cselect_b32 s38, s38, 2048
    s_add_u32 s28, s28, s38
    s_add_u32 m0, s31, 135168
    s_add_u32 s29, s29, 1
    buffer_load_dwordx4 v6, s[4:7], s28 offen offset:0 sc1 lds
    buffer_load_dwordx4 v6, s[4:7], s28 offen offset:1024 sc1 lds
    buffer_load_dwordx4 v26, s[4:7], s28 offen offset:2048 sc1 lds
    buffer_load_dwordx4 v26, s[4:7], s28 offen offset:3072 sc1 lds
    s_cmp_eq_u32 s29, 10
    s_cselect_b32 s38, -18432, 0
    s_cselect_b32 s29, 0, s29
    s_cselect_b32 s38, s38, 2048
    s_add_u32 s28, s28, s38
    v_and_b32 v3, 15, v1
    v_lshlrev_b32 v2, 3, v3
    v_lshl_add_u32 v2, v9, 15, v2
    v_add_u32 v3, 16384, v2
    s_lshl_b32 s38, s45, 7
    s_add_u32 s38, s38, 2883584
    buffer_load_dwordx2 v[30:31], v2, s[4:7], s38 offen sc1
    buffer_load_dwordx2 v[32:33], v3, s[4:7], s38 offen sc1
    s_waitcnt vmcnt(14)
    s_barrier
    s_waitcnt vmcnt(10)
    s_barrier
    s_add_u32 m0, s30, 28672
    s_add_u32 s27, s27, 1
    buffer_load_dwordx4 v25, s[4:7], s26 offen offset:0 sc1 lds
    buffer_load_dwordx4 v25, s[4:7], s26 offen offset:1024 sc1 lds
    buffer_load_dwordx4 v25, s[4:7], s26 offen offset:2048 sc1 lds
    s_mov_b32 exec_hi, 0
    buffer_load_dwordx4 v25, s[4:7], s26 offen offset:3072 sc1 lds
    s_mov_b32 exec_hi, -1
    s_cmp_eq_u32 s27, 10
    s_cselect_b32 s38, -129024, 0
    s_cselect_b32 s27, 0, s27
    s_cselect_b32 s38, s38, 14336
    s_add_u32 s26, s26, s38
    s_add_u32 m0, s31, 86016
    s_add_u32 s29, s29, 1
    buffer_load_dwordx4 v6, s[4:7], s28 offen offset:0 sc1 lds
    buffer_load_dwordx4 v6, s[4:7], s28 offen offset:1024 sc1 lds
    buffer_load_dwordx4 v26, s[4:7], s28 offen offset:2048 sc1 lds
    buffer_load_dwordx4 v26, s[4:7], s28 offen offset:3072 sc1 lds
    s_cmp_eq_u32 s29, 10
    s_cselect_b32 s38, -18432, 0
    s_cselect_b32 s29, 0, s29
    s_cselect_b32 s38, s38, 2048
    s_add_u32 s28, s28, s38
    s_waitcnt vmcnt(14)
    s_barrier
    s_add_u32 m0, s30, 43008
    s_add_u32 s27, s27, 1
    buffer_load_dwordx4 v25, s[4:7], s26 offen offset:0 sc1 lds
    buffer_load_dwordx4 v25, s[4:7], s26 offen offset:1024 sc1 lds
    buffer_load_dwordx4 v25, s[4:7], s26 offen offset:2048 sc1 lds
    s_mov_b32 exec_hi, 0
    buffer_load_dwordx4 v25, s[4:7], s26 offen offset:3072 sc1 lds
    s_mov_b32 exec_hi, -1
    s_cmp_eq_u32 s27, 10
    s_cselect_b32 s38, -129024, 0
    s_cselect_b32 s27, 0, s27
    s_cselect_b32 s38, s38, 14336
    s_add_u32 s26, s26, s38
    s_add_u32 m0, s31, 102400
    s_add_u32 s29, s29, 1
    buffer_load_dwordx4 v6, s[4:7], s28 offen offset:0 sc1 lds
    buffer_load_dwordx4 v6, s[4:7], s28 offen offset:1024 sc1 lds
    buffer_load_dwordx4 v26, s[4:7], s28 offen offset:2048 sc1 lds
    buffer_load_dwordx4 v26, s[4:7], s28 offen offset:3072 sc1 lds
    s_cmp_eq_u32 s29, 10
    s_cselect_b32 s38, -18432, 0
    s_cselect_b32 s29, 0, s29
    s_cselect_b32 s38, s38, 2048
    s_add_u32 s28, s28, s38
    s_waitcnt vmcnt(18)
    s_barrier
    s_add_u32 m0, s30, 57344
    s_add_u32 s27, s27, 1
    buffer_load_dwordx4 v25, s[4:7], s26 offen offset:0 sc1 lds
    buffer_load_dwordx4 v25, s[4:7], s26 offen offset:1024 sc1 lds
    buffer_load_dwordx4 v25, s[4:7], s26 offen offset:2048 sc1 lds
    s_mov_b32 exec_hi, 0
    buffer_load_dwordx4 v25, s[4:7], s26 offen offset:3072 sc1 lds
    s_mov_b32 exec_hi, -1
    s_cmp_eq_u32 s27, 10
    s_cselect_b32 s38, -129024, 0
    s_cselect_b32 s27, 0, s27
    s_cselect_b32 s38, s38, 14336
    s_add_u32 s26, s26, s38
    s_add_u32 m0, s31, 118784
    s_add_u32 s29, s29, 1
    buffer_load_dwordx4 v6, s[4:7], s28 offen offset:0 sc1 lds
    buffer_load_dwordx4 v6, s[4:7], s28 offen offset:1024 sc1 lds
    buffer_load_dwordx4 v26, s[4:7], s28 offen offset:2048 sc1 lds
    buffer_load_dwordx4 v26, s[4:7], s28 offen offset:3072 sc1 lds
    s_cmp_eq_u32 s29, 10
    s_cselect_b32 s38, -18432, 0
    s_cselect_b32 s29, 0, s29
    s_cselect_b32 s38, s38, 2048
    s_add_u32 s28, s28, s38
    s_waitcnt vmcnt(16)
    s_barrier
    s_add_u32 m0, s30, 71680
    s_add_u32 s27, s27, 1
    buffer_load_dwordx4 v25, s[4:7], s26 offen offset:0 sc1 lds
    buffer_load_dwordx4 v25, s[4:7], s26 offen offset:1024 sc1 lds
    buffer_load_dwordx4 v25, s[4:7], s26 offen offset:2048 sc1 lds
    s_mov_b32 exec_hi, 0
    buffer_load_dwordx4 v25, s[4:7], s26 offen offset:3072 sc1 lds
    s_mov_b32 exec_hi, -1
    s_cmp_eq_u32 s27, 10
    s_cselect_b32 s38, -129024, 0
    s_cselect_b32 s27, 0, s27
    s_cselect_b32 s38, s38, 14336
    s_add_u32 s26, s26, s38
    s_add_u32 m0, s31, 135168
    s_add_u32 s29, s29, 1
    buffer_load_dwordx4 v6, s[4:7], s28 offen offset:0 sc1 lds
    buffer_load_dwordx4 v6, s[4:7], s28 offen offset:1024 sc1 lds
    buffer_load_dwordx4 v26, s[4:7], s28 offen offset:2048 sc1 lds
    buffer_load_dwordx4 v26, s[4:7], s28 offen offset:3072 sc1 lds
    s_cmp_eq_u32 s29, 10
    s_cselect_b32 s38, -18432, 0
    s_cselect_b32 s29, 0, s29
    s_cselect_b32 s38, s38, 2048
    s_add_u32 s28, s28, s38
    s_waitcnt vmcnt(16)
    s_barrier
    s_add_u32 m0, s31, 86016
    s_add_u32 s29, s29, 1
    buffer_load_dwordx4 v6, s[4:7], s28 offen offset:0 sc1 lds
    buffer_load_dwordx4 v6, s[4:7], s28 offen offset:1024 sc1 lds
    buffer_load_dwordx4 v26, s[4:7], s28 offen offset:2048 sc1 lds
    buffer_load_dwordx4 v26, s[4:7], s28 offen offset:3072 sc1 lds
    s_cmp_eq_u32 s29, 10
    s_cselect_b32 s38, -18432, 0
    s_cselect_b32 s29, 0, s29
    s_cselect_b32 s38, s38, 2048
    s_add_u32 s28, s28, s38
    s_mul_i32 s26, s19, 27
    s_add_u32 s26, s26, s20
    s_mul_i32 s26, s26, 10240
    s_add_u32 s26, s26, 19398656
    s_mov_b32 s27, s20
    s_mul_i32 s30, s62, 2560
    s_add_u32 m0, s30, 0
    s_add_u32 s27, s27, 1
    buffer_load_dwordx4 v24, s[4:7], s26 offen offset:0 sc1 lds
    buffer_load_dwordx4 v24, s[4:7], s26 offen offset:1024 sc1 lds
    s_mov_b32 exec_hi, 0
    buffer_load_dwordx4 v24, s[4:7], s26 offen offset:2048 sc1 lds
    s_mov_b32 exec_hi, -1
    s_cmp_eq_u32 s27, 27
    s_cselect_b32 s38, -266240, 0
    s_cselect_b32 s27, 0, s27
    s_cselect_b32 s38, s38, 10240
    s_add_u32 s26, s26, s38
    s_waitcnt vmcnt(15)
    s_barrier
    s_add_u32 m0, s31, 102400
    s_add_u32 s29, s29, 1
    buffer_load_dwordx4 v6, s[4:7], s28 offen offset:0 sc1 lds
    buffer_load_dwordx4 v6, s[4:7], s28 offen offset:1024 sc1 lds
    buffer_load_dwordx4 v26, s[4:7], s28 offen offset:2048 sc1 lds
    buffer_load_dwordx4 v26, s[4:7], s28 offen offset:3072 sc1 lds
    s_cmp_eq_u32 s29, 10
    s_cselect_b32 s38, -18432, 0
    s_cselect_b32 s29, 0, s29
    s_cselect_b32 s38, s38, 2048
    s_add_u32 s28, s28, s38
    s_add_u32 m0, s30, 10240
    s_add_u32 s27, s27, 1
    buffer_load_dwordx4 v24, s[4:7], s26 offen offset:0 sc1 lds
    buffer_load_dwordx4 v24, s[4:7], s26 offen offset:1024 sc1 lds
    s_mov_b32 exec_hi, 0
    buffer_load_dwordx4 v24, s[4:7], s26 offen offset:2048 sc1 lds
    s_mov_b32 exec_hi, -1
    s_cmp_eq_u32 s27, 27
    s_cselect_b32 s38, -266240, 0
    s_cselect_b32 s27, 0, s27
    s_cselect_b32 s38, s38, 10240
    s_add_u32 s26, s26, s38
    s_waitcnt vmcnt(14)
    s_barrier
    s_add_u32 m0, s30, 20480
    s_add_u32 s27, s27, 1
    buffer_load_dwordx4 v24, s[4:7], s26 offen offset:0 sc1 lds
    buffer_load_dwordx4 v24, s[4:7], s26 offen offset:1024 sc1 lds
    s_mov_b32 exec_hi, 0
    buffer_load_dwordx4 v24, s[4:7], s26 offen offset:2048 sc1 lds
    s_mov_b32 exec_hi, -1
    s_cmp_eq_u32 s27, 27
    s_cselect_b32 s38, -266240, 0
    s_cselect_b32 s27, 0, s27
    s_cselect_b32 s38, s38, 10240
    s_add_u32 s26, s26, s38
    s_add_u32 m0, s30, 30720
    s_add_u32 s27, s27, 1
    buffer_load_dwordx4 v24, s[4:7], s26 offen offset:0 sc1 lds
    buffer_load_dwordx4 v24, s[4:7], s26 offen offset:1024 sc1 lds
    s_mov_b32 exec_hi, 0
    buffer_load_dwordx4 v24, s[4:7], s26 offen offset:2048 sc1 lds
    s_mov_b32 exec_hi, -1
    s_cmp_eq_u32 s27, 27
    s_cselect_b32 s38, -266240, 0
    s_cselect_b32 s27, 0, s27
    s_cselect_b32 s38, s38, 10240
    s_add_u32 s26, s26, s38
    s_waitcnt vmcnt(16)
    s_barrier
    s_add_u32 m0, s30, 40960
    s_add_u32 s27, s27, 1
    buffer_load_dwordx4 v24, s[4:7], s26 offen offset:0 sc1 lds
    buffer_load_dwordx4 v24, s[4:7], s26 offen offset:1024 sc1 lds
    s_mov_b32 exec_hi, 0
    buffer_load_dwordx4 v24, s[4:7], s26 offen offset:2048 sc1 lds
    s_mov_b32 exec_hi, -1
    s_cmp_eq_u32 s27, 27
    s_cselect_b32 s38, -266240, 0
    s_cselect_b32 s27, 0, s27
    s_cselect_b32 s38, s38, 10240
    s_add_u32 s26, s26, s38
    s_waitcnt vmcnt(12)
    s_barrier
    s_barrier
    s_mul_i32 s38, s62, 7168
    s_add_u32 s38, s38, 112640
    v_add_u32 v2, s38, v6
    s_barrier
    ds_read_b128 v[112:115], v2 offset:0
    ds_read_b128 v[116:119], v2 offset:1024
    ds_read_b128 v[120:123], v2 offset:2048
    ds_read_b128 v[124:127], v2 offset:3072
    ds_read_b128 v[128:131], v2 offset:4096
    ds_read_b128 v[132:135], v2 offset:5120
    ds_read_b128 v[136:139], v2 offset:6144
    v_lshlrev_b32 v2, 4, v9
    v_add_u32 v2, 153600, v2
    ds_read_b128 v[40:43], v2 offset:0
    ds_read_b128 v[44:47], v2 offset:64
    ds_read_b128 v[48:51], v2 offset:128
    ds_read_b128 v[52:55], v2 offset:192
    ds_read_b128 v[56:59], v2 offset:256
    ds_read_b128 v[60:63], v2 offset:320
    ds_read_b128 v[64:67], v2 offset:384
    v_add_f32 v30, v30, v32
    v_add_f32 v31, v31, v33
    v_mov_b32 v12, v30
    s_nop 1
    v_permlane16_swap_b32 v30, v12
    s_nop 1
    v_add_f32 v30, v30, v12
    v_mov_b32 v12, v30
    s_nop 1
    v_permlane32_swap_b32 v30, v12
    s_nop 1
    v_add_f32 v30, v30, v12
    v_mov_b32 v12, v31
    s_nop 1
    v_permlane16_swap_b32 v31, v12
    s_nop 1
    v_add_f32 v31, v31, v12
    v_mov_b32 v12, v31
    s_nop 1
    v_permlane32_swap_b32 v31, v12
    s_nop 1
    v_add_f32 v31, v31, v12
    v_mul_f32 v30, 0xbacccccd, v30
    v_mul_f32 v12, 0x3acccccd, v31
    v_fma_f32 v12, -v30, v30, v12
    v_max_f32 v12, 0, v12
    v_add_f32 v12, 0x3727c5ac, v12
    v_rsq_f32 v31, v12
    v_and_b32 v2, 15, v1
    v_mul_f32 v32, 0xbfb8aa3b, v31
    v_and_b32 v5, 1, v9
    v_lshrrev_b32 v4, 1, v9
    v_lshlrev_b32 v3, 4, v2
    v_lshl_add_u32 v3, v4, 8, v3
    v_lshl_add_u32 v4, v5, 3, v3
    v_lshl_add_u32 v3, v5, 9, v3
    s_waitcnt lgkmcnt(0)
    v_pk_fma_f32 v[112:113], v[40:41], v[30:31], v[112:113] op_sel_hi:[1,0,1]
    v_pk_fma_f32 v[114:115], v[42:43], v[30:31], v[114:115] op_sel_hi:[1,0,1]
    v_pk_mul_f32 v[12:13], v[112:113], v[32:33] op_sel_hi:[1,0]
    v_pk_mul_f32 v[14:15], v[114:115], v[32:33] op_sel_hi:[1,0]
    v_exp_f32 v12, v12
    v_exp_f32 v13, v13
    v_exp_f32 v14, v14
    v_exp_f32 v15, v15
    v_pk_mul_f32 v[112:113], v[112:113], v[30:31] op_sel:[0,1] op_sel_hi:[1,1]
    v_pk_mul_f32 v[114:115], v[114:115], v[30:31] op_sel:[0,1] op_sel_hi:[1,1]
    v_pk_fma_f32 v[116:117], v[44:45], v[30:31], v[116:117] op_sel_hi:[1,0,1]
    v_pk_fma_f32 v[118:119], v[46:47], v[30:31], v[118:119] op_sel_hi:[1,0,1]
    v_pk_mul_f32 v[16:17], v[116:117], v[32:33] op_sel_hi:[1,0]
    v_pk_mul_f32 v[18:19], v[118:119], v[32:33] op_sel_hi:[1,0]
    v_exp_f32 v16, v16
    v_exp_f32 v17, v17
    v_exp_f32 v18, v18
    v_exp_f32 v19, v19
    v_pk_mul_f32 v[116:117], v[116:117], v[30:31] op_sel:[0,1] op_sel_hi:[1,1]
    v_pk_mul_f32 v[118:119], v[118:119], v[30:31] op_sel:[0,1] op_sel_hi:[1,1]
    v_pk_add_f32 v[12:13], v[12:13], 1.0 op_sel_hi:[1,0]
    v_pk_add_f32 v[14:15], v[14:15], 1.0 op_sel_hi:[1,0]
    v_rcp_f32 v12, v12
    v_rcp_f32 v13, v13
    v_rcp_f32 v14, v14
    v_rcp_f32 v15, v15
    v_pk_add_f32 v[16:17], v[16:17], 1.0 op_sel_hi:[1,0]
    v_pk_add_f32 v[18:19], v[18:19], 1.0 op_sel_hi:[1,0]
    v_rcp_f32 v16, v16
    v_rcp_f32 v17, v17
    v_rcp_f32 v18, v18
    v_rcp_f32 v19, v19
    v_pk_mul_f32 v[112:113], v[112:113], v[12:13]
    v_pk_mul_f32 v[114:115], v[114:115], v[14:15]
    v_cvt_pk_bf16_f32 v72, v112, v113
    v_cvt_pk_bf16_f32 v73, v114, v115
    v_pk_mul_f32 v[116:117], v[116:117], v[16:17]
    v_pk_mul_f32 v[118:119], v[118:119], v[18:19]
    v_cvt_pk_bf16_f32 v74, v116, v117
    v_cvt_pk_bf16_f32 v75, v118, v119
    s_nop 1
    v_permlane16_swap_b32 v72, v74
    v_permlane16_swap_b32 v73, v75
    buffer_store_dwordx4 v[72:75], v3, s[4:7], s46 offen offset:0 sc1
    v_pk_fma_f32 v[120:121], v[48:49], v[30:31], v[120:121] op_sel_hi:[1,0,1]
    v_pk_fma_f32 v[122:123], v[50:51], v[30:31], v[122:123] op_sel_hi:[1,0,1]
    v_pk_mul_f32 v[12:13], v[120:121], v[32:33] op_sel_hi:[1,0]
    v_pk_mul_f32 v[14:15], v[122:123], v[32:33] op_sel_hi:[1,0]
    v_exp_f32 v12, v12
    v_exp_f32 v13, v13
    v_exp_f32 v14, v14
    v_exp_f32 v15, v15
    v_pk_mul_f32 v[120:121], v[120:121], v[30:31] op_sel:[0,1] op_sel_hi:[1,1]
    v_pk_mul_f32 v[122:123], v[122:123], v[30:31] op_sel:[0,1] op_sel_hi:[1,1]
    v_pk_fma_f32 v[124:125], v[52:53], v[30:31], v[124:125] op_sel_hi:[1,0,1]
    v_pk_fma_f32 v[126:127], v[54:55], v[30:31], v[126:127] op_sel_hi:[1,0,1]
    v_pk_mul_f32 v[16:17], v[124:125], v[32:33] op_sel_hi:[1,0]
    v_pk_mul_f32 v[18:19], v[126:127], v[32:33] op_sel_hi:[1,0]
    v_exp_f32 v16, v16
    v_exp_f32 v17, v17
    v_exp_f32 v18, v18
    v_exp_f32 v19, v19
    v_pk_mul_f32 v[124:125], v[124:125], v[30:31] op_sel:[0,1] op_sel_hi:[1,1]
    v_pk_mul_f32 v[126:127], v[126:127], v[30:31] op_sel:[0,1] op_sel_hi:[1,1]
    v_pk_add_f32 v[12:13], v[12:13], 1.0 op_sel_hi:[1,0]
    v_pk_add_f32 v[14:15], v[14:15], 1.0 op_sel_hi:[1,0]
    v_rcp_f32 v12, v12
    v_rcp_f32 v13, v13
    v_rcp_f32 v14, v14
    v_rcp_f32 v15, v15
    v_pk_add_f32 v[16:17], v[16:17], 1.0 op_sel_hi:[1,0]
    v_pk_add_f32 v[18:19], v[18:19], 1.0 op_sel_hi:[1,0]
    v_rcp_f32 v16, v16
    v_rcp_f32 v17, v17
    v_rcp_f32 v18, v18
    v_rcp_f32 v19, v19
    v_pk_mul_f32 v[120:121], v[120:121], v[12:13]
    v_pk_mul_f32 v[122:123], v[122:123], v[14:15]
    v_cvt_pk_bf16_f32 v76, v120, v121
    v_cvt_pk_bf16_f32 v77, v122, v123
    v_pk_mul_f32 v[124:125], v[124:125], v[16:17]
    v_pk_mul_f32 v[126:127], v[126:127], v[18:19]
    v_cvt_pk_bf16_f32 v78, v124, v125
    v_cvt_pk_bf16_f32 v79, v126, v127
    s_nop 1
    v_permlane16_swap_b32 v76, v78
    v_permlane16_swap_b32 v77, v79
    buffer_store_dwordx4 v[76:79], v3, s[4:7], s46 offen offset:1024 sc1
    v_pk_fma_f32 v[128:129], v[56:57], v[30:31], v[128:129] op_sel_hi:[1,0,1]
    v_pk_fma_f32 v[130:131], v[58:59], v[30:31], v[130:131] op_sel_hi:[1,0,1]
    v_pk_mul_f32 v[12:13], v[128:129], v[32:33] op_sel_hi:[1,0]
    v_pk_mul_f32 v[14:15], v[130:131], v[32:33] op_sel_hi:[1,0]
    v_exp_f32 v12, v12
    v_exp_f32 v13, v13
    v_exp_f32 v14, v14
    v_exp_f32 v15, v15
    v_pk_mul_f32 v[128:129], v[128:129], v[30:31] op_sel:[0,1] op_sel_hi:[1,1]
    v_pk_mul_f32 v[130:131], v[130:131], v[30:31] op_sel:[0,1] op_sel_hi:[1,1]
    v_pk_fma_f32 v[132:133], v[60:61], v[30:31], v[132:133] op_sel_hi:[1,0,1]
    v_pk_fma_f32 v[134:135], v[62:63], v[30:31], v[134:135] op_sel_hi:[1,0,1]
    v_pk_mul_f32 v[16:17], v[132:133], v[32:33] op_sel_hi:[1,0]
    v_pk_mul_f32 v[18:19], v[134:135], v[32:33] op_sel_hi:[1,0]
    v_exp_f32 v16, v16
    v_exp_f32 v17, v17
    v_exp_f32 v18, v18
    v_exp_f32 v19, v19
    v_pk_mul_f32 v[132:133], v[132:133], v[30:31] op_sel:[0,1] op_sel_hi:[1,1]
    v_pk_mul_f32 v[134:135], v[134:135], v[30:31] op_sel:[0,1] op_sel_hi:[1,1]
    v_pk_add_f32 v[12:13], v[12:13], 1.0 op_sel_hi:[1,0]
    v_pk_add_f32 v[14:15], v[14:15], 1.0 op_sel_hi:[1,0]
    v_rcp_f32 v12, v12
    v_rcp_f32 v13, v13
    v_rcp_f32 v14, v14
    v_rcp_f32 v15, v15
    v_pk_add_f32 v[16:17], v[16:17], 1.0 op_sel_hi:[1,0]
    v_pk_add_f32 v[18:19], v[18:19], 1.0 op_sel_hi:[1,0]
    v_rcp_f32 v16, v16
    v_rcp_f32 v17, v17
    v_rcp_f32 v18, v18
    v_rcp_f32 v19, v19
    v_pk_mul_f32 v[128:129], v[128:129], v[12:13]
    v_pk_mul_f32 v[130:131], v[130:131], v[14:15]
    v_cvt_pk_bf16_f32 v80, v128, v129
    v_cvt_pk_bf16_f32 v81, v130, v131
    v_pk_mul_f32 v[132:133], v[132:133], v[16:17]
    v_pk_mul_f32 v[134:135], v[134:135], v[18:19]
    v_cvt_pk_bf16_f32 v82, v132, v133
    v_cvt_pk_bf16_f32 v83, v134, v135
    s_nop 1
    v_permlane16_swap_b32 v80, v82
    v_permlane16_swap_b32 v81, v83
    buffer_store_dwordx4 v[80:83], v3, s[4:7], s46 offen offset:2048 sc1
    s_cmp_lt_u32 s43, 7
    s_cbranch_scc1 sequential_preLN__grouped_kv_mqa__dense_activation_silu__prompt_kernel_Dl_sk
    v_pk_fma_f32 v[136:137], v[64:65], v[30:31], v[136:137] op_sel_hi:[1,0,1]
    v_pk_fma_f32 v[138:139], v[66:67], v[30:31], v[138:139] op_sel_hi:[1,0,1]
    v_pk_mul_f32 v[12:13], v[136:137], v[32:33] op_sel_hi:[1,0]
    v_pk_mul_f32 v[14:15], v[138:139], v[32:33] op_sel_hi:[1,0]
    v_exp_f32 v12, v12
    v_exp_f32 v13, v13
    v_exp_f32 v14, v14
    v_exp_f32 v15, v15
    v_pk_mul_f32 v[136:137], v[136:137], v[30:31] op_sel:[0,1] op_sel_hi:[1,1]
    v_pk_mul_f32 v[138:139], v[138:139], v[30:31] op_sel:[0,1] op_sel_hi:[1,1]
    v_pk_add_f32 v[12:13], v[12:13], 1.0 op_sel_hi:[1,0]
    v_pk_add_f32 v[14:15], v[14:15], 1.0 op_sel_hi:[1,0]
    v_rcp_f32 v12, v12
    v_rcp_f32 v13, v13
    v_rcp_f32 v14, v14
    v_rcp_f32 v15, v15
    s_nop 0
    v_pk_mul_f32 v[136:137], v[136:137], v[12:13]
    v_pk_mul_f32 v[138:139], v[138:139], v[14:15]
    v_cvt_pk_bf16_f32 v84, v136, v137
    v_cvt_pk_bf16_f32 v85, v138, v139
    buffer_store_dwordx2 v[84:85], v4, s[4:7], s46 offen offset:3072 sc1
sequential_preLN__grouped_kv_mqa__dense_activation_silu__prompt_kernel_Dl_sk:
    s_lshl_b32 s38, s18, 2
    s_add_u32 s38, s38, s62
    s_mul_i32 s28, s38, 55296
    s_lshl_b32 s38, s20, 11
    s_add_u32 s28, s28, s38
    s_add_u32 s28, s28, 8388608
    s_mov_b32 s29, s20
    s_mul_i32 s31, s62, 2048
    s_lshl_b32 s32, s15, 15
    s_lshl_b32 s38, s16, 7
    s_waitcnt vmcnt(0)
    s_add_u32 s32, s32, s38
    s_add_u32 s32, s32, 23068672
    s_lshl_b32 s41, s18, 3
    s_add_u32 s41, s41, s19
    s_lshl_b32 s41, s41, 11
    s_add_u32 s41, s41, 23068672
    s_barrier
    s_cmp_lg_u32 s3, 4
    s_cbranch_scc1 sequential_preLN__grouped_kv_mqa__dense_activation_silu__prompt_kernel_nqE
    s_mov_b64 exec, 65535
    buffer_store_dword v28, v27, s[4:7], s32 offen sc1
    s_mov_b64 exec, -1
sequential_preLN__grouped_kv_mqa__dense_activation_silu__prompt_kernel_nqE:
    s_add_u32 m0, s30, 51200
    s_add_u32 s27, s27, 1
    buffer_load_dwordx4 v24, s[4:7], s26 offen offset:0 sc1 lds
    buffer_load_dwordx4 v24, s[4:7], s26 offen offset:1024 sc1 lds
    s_mov_b32 exec_hi, 0
    buffer_load_dwordx4 v24, s[4:7], s26 offen offset:2048 sc1 lds
    s_mov_b32 exec_hi, -1
    s_cmp_eq_u32 s27, 27
    s_cselect_b32 s38, -266240, 0
    s_cselect_b32 s27, 0, s27
    s_cselect_b32 s38, s38, 10240
    s_add_u32 s26, s26, s38
    s_add_u32 m0, s30, 61440
    s_add_u32 s27, s27, 1
    buffer_load_dwordx4 v24, s[4:7], s26 offen offset:0 sc1 lds
    buffer_load_dwordx4 v24, s[4:7], s26 offen offset:1024 sc1 lds
    s_mov_b32 exec_hi, 0
    buffer_load_dwordx4 v24, s[4:7], s26 offen offset:2048 sc1 lds
    s_mov_b32 exec_hi, -1
    s_cmp_eq_u32 s27, 27
    s_cselect_b32 s38, -266240, 0
    s_cselect_b32 s27, 0, s27
    s_cselect_b32 s38, s38, 10240
    s_add_u32 s26, s26, s38
    s_add_u32 m0, s30, 71680
    s_add_u32 s27, s27, 1
    buffer_load_dwordx4 v24, s[4:7], s26 offen offset:0 sc1 lds
    buffer_load_dwordx4 v24, s[4:7], s26 offen offset:1024 sc1 lds
    s_mov_b32 exec_hi, 0
    buffer_load_dwordx4 v24, s[4:7], s26 offen offset:2048 sc1 lds
    s_mov_b32 exec_hi, -1
    s_cmp_eq_u32 s27, 27
    s_cselect_b32 s38, -266240, 0
    s_cselect_b32 s27, 0, s27
    s_cselect_b32 s38, s38, 10240
    s_add_u32 s26, s26, s38
    s_add_u32 m0, s30, 81920
    s_add_u32 s27, s27, 1
    buffer_load_dwordx4 v24, s[4:7], s26 offen offset:0 sc1 lds
    buffer_load_dwordx4 v24, s[4:7], s26 offen offset:1024 sc1 lds
    s_mov_b32 exec_hi, 0
    buffer_load_dwordx4 v24, s[4:7], s26 offen offset:2048 sc1 lds
    s_mov_b32 exec_hi, -1
    s_cmp_eq_u32 s27, 27
    s_cselect_b32 s38, -266240, 0
    s_cselect_b32 s27, 0, s27
    s_cselect_b32 s38, s38, 10240
    s_add_u32 s26, s26, s38
    s_add_u32 m0, s30, 92160
    s_add_u32 s27, s27, 1
    buffer_load_dwordx4 v24, s[4:7], s26 offen offset:0 sc1 lds
    buffer_load_dwordx4 v24, s[4:7], s26 offen offset:1024 sc1 lds
    s_mov_b32 exec_hi, 0
    buffer_load_dwordx4 v24, s[4:7], s26 offen offset:2048 sc1 lds
    s_mov_b32 exec_hi, -1
    s_cmp_eq_u32 s27, 27
    s_cselect_b32 s38, -266240, 0
    s_cselect_b32 s27, 0, s27
    s_cselect_b32 s38, s38, 10240
    s_add_u32 s26, s26, s38
    s_add_u32 m0, s30, 102400
    s_add_u32 s27, s27, 1
    buffer_load_dwordx4 v24, s[4:7], s26 offen offset:0 sc1 lds
    buffer_load_dwordx4 v24, s[4:7], s26 offen offset:1024 sc1 lds
    s_mov_b32 exec_hi, 0
    buffer_load_dwordx4 v24, s[4:7], s26 offen offset:2048 sc1 lds
    s_mov_b32 exec_hi, -1
    s_cmp_eq_u32 s27, 27
    s_cselect_b32 s38, -266240, 0
    s_cselect_b32 s27, 0, s27
    s_cselect_b32 s38, s38, 10240
    s_add_u32 s26, s26, s38
    s_cmp_lg_u32 s3, 4
    s_cbranch_scc1 sequential_preLN__grouped_kv_mqa__dense_activation_silu__prompt_kernel_npE
    s_mov_b32 s39, 524288
    v_lshlrev_b32 v21, 7, v1
    s_mov_b64 exec, 65535
sequential_preLN__grouped_kv_mqa__dense_activation_silu__prompt_kernel_pollE:
    buffer_load_dword v20, v21, s[4:7], s41 offen sc1
sequential_preLN__grouped_kv_mqa__dense_activation_silu__prompt_kernel_pollwE:
    s_waitcnt vmcnt(0)
    v_xor_b32 v22, s100, v20
    v_cmp_ne_u32 vcc, 0, v22
    s_sub_u32 s39, s39, 1
    s_cbranch_scc1 sequential_preLN__grouped_kv_mqa__dense_activation_silu__prompt_kernel_pollxE
    s_nop 1
    s_cmp_eq_u64 vcc, 0
    s_cbranch_scc1 sequential_preLN__grouped_kv_mqa__dense_activation_silu__prompt_kernel_pollxE
    s_sleep 2
    s_branch sequential_preLN__grouped_kv_mqa__dense_activation_silu__prompt_kernel_pollE
sequential_preLN__grouped_kv_mqa__dense_activation_silu__prompt_kernel_pollxE:
    s_mov_b64 exec, -1
sequential_preLN__grouped_kv_mqa__dense_activation_silu__prompt_kernel_npE:
    s_barrier
    s_add_u32 m0, s31, 112640
    s_add_u32 s29, s29, 1
    buffer_load_dwordx4 v6, s[4:7], s28 offen offset:0 sc1 lds
    buffer_load_dwordx4 v6, s[4:7], s28 offen offset:1024 sc1 lds
    s_cmp_eq_u32 s29, 27
    s_cselect_b32 s38, -53248, 0
    s_cselect_b32 s29, 0, s29
    s_cselect_b32 s38, s38, 2048
    s_add_u32 s28, s28, s38
    s_add_u32 m0, s31, 120832
    s_add_u32 s29, s29, 1
    buffer_load_dwordx4 v6, s[4:7], s28 offen offset:0 sc1 lds
    buffer_load_dwordx4 v6, s[4:7], s28 offen offset:1024 sc1 lds
    s_cmp_eq_u32 s29, 27
    s_cselect_b32 s38, -53248, 0
    s_cselect_b32 s29, 0, s29
    s_cselect_b32 s38, s38, 2048
    s_add_u32 s28, s28, s38
    s_add_u32 m0, s31, 129024
    s_add_u32 s29, s29, 1
    buffer_load_dwordx4 v6, s[4:7], s28 offen offset:0 sc1 lds
    buffer_load_dwordx4 v6, s[4:7], s28 offen offset:1024 sc1 lds
    s_cmp_eq_u32 s29, 27
    s_cselect_b32 s38, -53248, 0
    s_cselect_b32 s29, 0, s29
    s_cselect_b32 s38, s38, 2048
    s_add_u32 s28, s28, s38
    s_add_u32 m0, s31, 137216
    s_add_u32 s29, s29, 1
    buffer_load_dwordx4 v6, s[4:7], s28 offen offset:0 sc1 lds
    buffer_load_dwordx4 v6, s[4:7], s28 offen offset:1024 sc1 lds
    s_cmp_eq_u32 s29, 27
    s_cselect_b32 s38, -53248, 0
    s_cselect_b32 s29, 0, s29
    s_cselect_b32 s38, s38, 2048
    s_add_u32 s28, s28, s38
    s_add_u32 m0, s31, 145408
    s_add_u32 s29, s29, 1
    buffer_load_dwordx4 v6, s[4:7], s28 offen offset:0 sc1 lds
    buffer_load_dwordx4 v6, s[4:7], s28 offen offset:1024 sc1 lds
    s_cmp_eq_u32 s29, 27
    s_cselect_b32 s38, -53248, 0
    s_cselect_b32 s29, 0, s29
    s_cselect_b32 s38, s38, 2048
    s_add_u32 s28, s28, s38
    s_waitcnt vmcnt(8)
    s_barrier
    s_waitcnt vmcnt(6)
    s_barrier
    s_add_u32 m0, s30, 0
    s_add_u32 s27, s27, 1
    buffer_load_dwordx4 v24, s[4:7], s26 offen offset:0 sc1 lds
    buffer_load_dwordx4 v24, s[4:7], s26 offen offset:1024 sc1 lds
    s_mov_b32 exec_hi, 0
    buffer_load_dwordx4 v24, s[4:7], s26 offen offset:2048 sc1 lds
    s_mov_b32 exec_hi, -1
    s_cmp_eq_u32 s27, 27
    s_cselect_b32 s38, -266240, 0
    s_cselect_b32 s27, 0, s27
    s_cselect_b32 s38, s38, 10240
    s_add_u32 s26, s26, s38
    s_add_u32 m0, s31, 112640
    s_add_u32 s29, s29, 1
    buffer_load_dwordx4 v6, s[4:7], s28 offen offset:0 sc1 lds
    buffer_load_dwordx4 v6, s[4:7], s28 offen offset:1024 sc1 lds
    s_cmp_eq_u32 s29, 27
    s_cselect_b32 s38, -53248, 0
    s_cselect_b32 s29, 0, s29
    s_cselect_b32 s38, s38, 2048
    s_add_u32 s28, s28, s38
    s_waitcnt vmcnt(9)
    s_barrier
    s_add_u32 m0, s30, 10240
    s_add_u32 s27, s27, 1
    buffer_load_dwordx4 v24, s[4:7], s26 offen offset:0 sc1 lds
    buffer_load_dwordx4 v24, s[4:7], s26 offen offset:1024 sc1 lds
    s_mov_b32 exec_hi, 0
    buffer_load_dwordx4 v24, s[4:7], s26 offen offset:2048 sc1 lds
    s_mov_b32 exec_hi, -1
    s_cmp_eq_u32 s27, 27
    s_cselect_b32 s38, -266240, 0
    s_cselect_b32 s27, 0, s27
    s_cselect_b32 s38, s38, 10240
    s_add_u32 s26, s26, s38
    s_add_u32 m0, s31, 120832
    s_add_u32 s29, s29, 1
    buffer_load_dwordx4 v6, s[4:7], s28 offen offset:0 sc1 lds
    buffer_load_dwordx4 v6, s[4:7], s28 offen offset:1024 sc1 lds
    s_cmp_eq_u32 s29, 27
    s_cselect_b32 s38, -53248, 0
    s_cselect_b32 s29, 0, s29
    s_cselect_b32 s38, s38, 2048
    s_add_u32 s28, s28, s38
    s_waitcnt vmcnt(12)
    s_barrier
    s_add_u32 m0, s30, 20480
    s_add_u32 s27, s27, 1
    buffer_load_dwordx4 v24, s[4:7], s26 offen offset:0 sc1 lds
    buffer_load_dwordx4 v24, s[4:7], s26 offen offset:1024 sc1 lds
    s_mov_b32 exec_hi, 0
    buffer_load_dwordx4 v24, s[4:7], s26 offen offset:2048 sc1 lds
    s_mov_b32 exec_hi, -1
    s_cmp_eq_u32 s27, 27
    s_cselect_b32 s38, -266240, 0
    s_cselect_b32 s27, 0, s27
    s_cselect_b32 s38, s38, 10240
    s_add_u32 s26, s26, s38
    s_add_u32 m0, s31, 129024
    s_add_u32 s29, s29, 1
    buffer_load_dwordx4 v6, s[4:7], s28 offen offset:0 sc1 lds
    buffer_load_dwordx4 v6, s[4:7], s28 offen offset:1024 sc1 lds
    s_cmp_eq_u32 s29, 27
    s_cselect_b32 s38, -53248, 0
    s_cselect_b32 s29, 0, s29
    s_cselect_b32 s38, s38, 2048
    s_add_u32 s28, s28, s38
    s_waitcnt vmcnt(15)
    s_barrier
    s_add_u32 m0, s30, 30720
    s_add_u32 s27, s27, 1
    buffer_load_dwordx4 v24, s[4:7], s26 offen offset:0 sc1 lds
    buffer_load_dwordx4 v24, s[4:7], s26 offen offset:1024 sc1 lds
    s_mov_b32 exec_hi, 0
    buffer_load_dwordx4 v24, s[4:7], s26 offen offset:2048 sc1 lds
    s_mov_b32 exec_hi, -1
    s_cmp_eq_u32 s27, 27
    s_cselect_b32 s38, -266240, 0
    s_cselect_b32 s27, 0, s27
    s_cselect_b32 s38, s38, 10240
    s_add_u32 s26, s26, s38
    s_add_u32 m0, s31, 137216
    s_add_u32 s29, s29, 1
    buffer_load_dwordx4 v6, s[4:7], s28 offen offset:0 sc1 lds
    buffer_load_dwordx4 v6, s[4:7], s28 offen offset:1024 sc1 lds
    s_cmp_eq_u32 s29, 27
    s_cselect_b32 s38, -53248, 0
    s_cselect_b32 s29, 0, s29
    s_cselect_b32 s38, s38, 2048
    s_add_u32 s28, s28, s38
    s_waitcnt vmcnt(15)
    s_barrier
    s_add_u32 m0, s30, 40960
    s_add_u32 s27, s27, 1
    buffer_load_dwordx4 v24, s[4:7], s26 offen offset:0 sc1 lds
    buffer_load_dwordx4 v24, s[4:7], s26 offen offset:1024 sc1 lds
    s_mov_b32 exec_hi, 0
    buffer_load_dwordx4 v24, s[4:7], s26 offen offset:2048 sc1 lds
    s_mov_b32 exec_hi, -1
    s_cmp_eq_u32 s27, 27
    s_cselect_b32 s38, -266240, 0
    s_cselect_b32 s27, 0, s27
    s_cselect_b32 s38, s38, 10240
    s_add_u32 s26, s26, s38
    s_add_u32 m0, s31, 145408
    s_add_u32 s29, s29, 1
    buffer_load_dwordx4 v6, s[4:7], s28 offen offset:0 sc1 lds
    buffer_load_dwordx4 v6, s[4:7], s28 offen offset:1024 sc1 lds
    s_cmp_eq_u32 s29, 27
    s_cselect_b32 s38, -53248, 0
    s_cselect_b32 s29, 0, s29
    s_cselect_b32 s38, s38, 2048
    s_add_u32 s28, s28, s38
    s_waitcnt vmcnt(15)
    s_barrier
    s_add_u32 m0, s30, 51200
    s_add_u32 s27, s27, 1
    buffer_load_dwordx4 v24, s[4:7], s26 offen offset:0 sc1 lds
    buffer_load_dwordx4 v24, s[4:7], s26 offen offset:1024 sc1 lds
    s_mov_b32 exec_hi, 0
    buffer_load_dwordx4 v24, s[4:7], s26 offen offset:2048 sc1 lds
    s_mov_b32 exec_hi, -1
    s_cmp_eq_u32 s27, 27
    s_cselect_b32 s38, -266240, 0
    s_cselect_b32 s27, 0, s27
    s_cselect_b32 s38, s38, 10240
    s_add_u32 s26, s26, s38
    s_add_u32 m0, s31, 112640
    s_add_u32 s29, s29, 1
    buffer_load_dwordx4 v6, s[4:7], s28 offen offset:0 sc1 lds
    buffer_load_dwordx4 v6, s[4:7], s28 offen offset:1024 sc1 lds
    s_cmp_eq_u32 s29, 27
    s_cselect_b32 s38, -53248, 0
    s_cselect_b32 s29, 0, s29
    s_cselect_b32 s38, s38, 2048
    s_add_u32 s28, s28, s38
    s_waitcnt vmcnt(15)
    s_barrier
    s_add_u32 m0, s30, 61440
    s_add_u32 s27, s27, 1
    buffer_load_dwordx4 v24, s[4:7], s26 offen offset:0 sc1 lds
    buffer_load_dwordx4 v24, s[4:7], s26 offen offset:1024 sc1 lds
    s_mov_b32 exec_hi, 0
    buffer_load_dwordx4 v24, s[4:7], s26 offen offset:2048 sc1 lds
    s_mov_b32 exec_hi, -1
    s_cmp_eq_u32 s27, 27
    s_cselect_b32 s38, -266240, 0
    s_cselect_b32 s27, 0, s27
    s_cselect_b32 s38, s38, 10240
    s_add_u32 s26, s26, s38
    s_add_u32 m0, s31, 120832
    s_add_u32 s29, s29, 1
    buffer_load_dwordx4 v6, s[4:7], s28 offen offset:0 sc1 lds
    buffer_load_dwordx4 v6, s[4:7], s28 offen offset:1024 sc1 lds
    s_cmp_eq_u32 s29, 27
    s_cselect_b32 s38, -53248, 0
    s_cselect_b32 s29, 0, s29
    s_cselect_b32 s38, s38, 2048
    s_add_u32 s28, s28, s38
    s_waitcnt vmcnt(15)
    s_barrier
    s_add_u32 m0, s30, 71680
    s_add_u32 s27, s27, 1
    buffer_load_dwordx4 v24, s[4:7], s26 offen offset:0 sc1 lds
    buffer_load_dwordx4 v24, s[4:7], s26 offen offset:1024 sc1 lds
    s_mov_b32 exec_hi, 0
    buffer_load_dwordx4 v24, s[4:7], s26 offen offset:2048 sc1 lds
    s_mov_b32 exec_hi, -1
    s_cmp_eq_u32 s27, 27
    s_cselect_b32 s38, -266240, 0
    s_cselect_b32 s27, 0, s27
    s_cselect_b32 s38, s38, 10240
    s_add_u32 s26, s26, s38
    s_add_u32 m0, s31, 129024
    s_add_u32 s29, s29, 1
    buffer_load_dwordx4 v6, s[4:7], s28 offen offset:0 sc1 lds
    buffer_load_dwordx4 v6, s[4:7], s28 offen offset:1024 sc1 lds
    s_cmp_eq_u32 s29, 27
    s_cselect_b32 s38, -53248, 0
    s_cselect_b32 s29, 0, s29
    s_cselect_b32 s38, s38, 2048
    s_add_u32 s28, s28, s38
    s_waitcnt vmcnt(15)
    s_barrier
    s_add_u32 m0, s30, 81920
    s_add_u32 s27, s27, 1
    buffer_load_dwordx4 v24, s[4:7], s26 offen offset:0 sc1 lds
    buffer_load_dwordx4 v24, s[4:7], s26 offen offset:1024 sc1 lds
    s_mov_b32 exec_hi, 0
    buffer_load_dwordx4 v24, s[4:7], s26 offen offset:2048 sc1 lds
    s_mov_b32 exec_hi, -1
    s_cmp_eq_u32 s27, 27
    s_cselect_b32 s38, -266240, 0
    s_cselect_b32 s27, 0, s27
    s_cselect_b32 s38, s38, 10240
    s_add_u32 s26, s26, s38
    s_add_u32 m0, s31, 137216
    s_add_u32 s29, s29, 1
    buffer_load_dwordx4 v6, s[4:7], s28 offen offset:0 sc1 lds
    buffer_load_dwordx4 v6, s[4:7], s28 offen offset:1024 sc1 lds
    s_cmp_eq_u32 s29, 27
    s_cselect_b32 s38, -53248, 0
    s_cselect_b32 s29, 0, s29
    s_cselect_b32 s38, s38, 2048
    s_add_u32 s28, s28, s38
    s_waitcnt vmcnt(15)
    s_barrier
    s_add_u32 m0, s30, 92160
    s_add_u32 s27, s27, 1
    buffer_load_dwordx4 v24, s[4:7], s26 offen offset:0 sc1 lds
    buffer_load_dwordx4 v24, s[4:7], s26 offen offset:1024 sc1 lds
    s_mov_b32 exec_hi, 0
    buffer_load_dwordx4 v24, s[4:7], s26 offen offset:2048 sc1 lds
    s_mov_b32 exec_hi, -1
    s_cmp_eq_u32 s27, 27
    s_cselect_b32 s38, -266240, 0
    s_cselect_b32 s27, 0, s27
    s_cselect_b32 s38, s38, 10240
    s_add_u32 s26, s26, s38
    s_add_u32 m0, s31, 145408
    s_add_u32 s29, s29, 1
    buffer_load_dwordx4 v6, s[4:7], s28 offen offset:0 sc1 lds
    buffer_load_dwordx4 v6, s[4:7], s28 offen offset:1024 sc1 lds
    s_cmp_eq_u32 s29, 27
    s_cselect_b32 s38, -53248, 0
    s_cselect_b32 s29, 0, s29
    s_cselect_b32 s38, s38, 2048
    s_add_u32 s28, s28, s38
    s_waitcnt vmcnt(15)
    s_barrier
    s_add_u32 m0, s30, 102400
    s_add_u32 s27, s27, 1
    buffer_load_dwordx4 v24, s[4:7], s26 offen offset:0 sc1 lds
    buffer_load_dwordx4 v24, s[4:7], s26 offen offset:1024 sc1 lds
    s_mov_b32 exec_hi, 0
    buffer_load_dwordx4 v24, s[4:7], s26 offen offset:2048 sc1 lds
    s_mov_b32 exec_hi, -1
    s_cmp_eq_u32 s27, 27
    s_cselect_b32 s38, -266240, 0
    s_cselect_b32 s27, 0, s27
    s_cselect_b32 s38, s38, 10240
    s_add_u32 s26, s26, s38
    s_add_u32 m0, s31, 112640
    s_add_u32 s29, s29, 1
    buffer_load_dwordx4 v6, s[4:7], s28 offen offset:0 sc1 lds
    buffer_load_dwordx4 v6, s[4:7], s28 offen offset:1024 sc1 lds
    s_cmp_eq_u32 s29, 27
    s_cselect_b32 s38, -53248, 0
    s_cselect_b32 s29, 0, s29
    s_cselect_b32 s38, s38, 2048
    s_add_u32 s28, s28, s38
    s_waitcnt vmcnt(15)
    s_barrier
    s_add_u32 m0, s30, 0
    s_add_u32 s27, s27, 1
    buffer_load_dwordx4 v24, s[4:7], s26 offen offset:0 sc1 lds
    buffer_load_dwordx4 v24, s[4:7], s26 offen offset:1024 sc1 lds
    s_mov_b32 exec_hi, 0
    buffer_load_dwordx4 v24, s[4:7], s26 offen offset:2048 sc1 lds
    s_mov_b32 exec_hi, -1
    s_cmp_eq_u32 s27, 27
    s_cselect_b32 s38, -266240, 0
    s_cselect_b32 s27, 0, s27
    s_cselect_b32 s38, s38, 10240
    s_add_u32 s26, s26, s38
    s_add_u32 m0, s31, 120832
    s_add_u32 s29, s29, 1
    buffer_load_dwordx4 v6, s[4:7], s28 offen offset:0 sc1 lds
    buffer_load_dwordx4 v6, s[4:7], s28 offen offset:1024 sc1 lds
    s_cmp_eq_u32 s29, 27
    s_cselect_b32 s38, -53248, 0
    s_cselect_b32 s29, 0, s29
    s_cselect_b32 s38, s38, 2048
    s_add_u32 s28, s28, s38
    s_waitcnt vmcnt(15)
    s_barrier
    s_add_u32 m0, s30, 10240
    s_add_u32 s27, s27, 1
    buffer_load_dwordx4 v24, s[4:7], s26 offen offset:0 sc1 lds
    buffer_load_dwordx4 v24, s[4:7], s26 offen offset:1024 sc1 lds
    s_mov_b32 exec_hi, 0
    buffer_load_dwordx4 v24, s[4:7], s26 offen offset:2048 sc1 lds
    s_mov_b32 exec_hi, -1
    s_cmp_eq_u32 s27, 27
    s_cselect_b32 s38, -266240, 0
    s_cselect_b32 s27, 0, s27
    s_cselect_b32 s38, s38, 10240
    s_add_u32 s26, s26, s38
    s_add_u32 m0, s31, 129024
    s_add_u32 s29, s29, 1
    buffer_load_dwordx4 v6, s[4:7], s28 offen offset:0 sc1 lds
    buffer_load_dwordx4 v6, s[4:7], s28 offen offset:1024 sc1 lds
    s_cmp_eq_u32 s29, 27
    s_cselect_b32 s38, -53248, 0
    s_cselect_b32 s29, 0, s29
    s_cselect_b32 s38, s38, 2048
    s_add_u32 s28, s28, s38
    s_waitcnt vmcnt(15)
    s_barrier
    s_add_u32 m0, s30, 20480
    s_add_u32 s27, s27, 1
    buffer_load_dwordx4 v24, s[4:7], s26 offen offset:0 sc1 lds
    buffer_load_dwordx4 v24, s[4:7], s26 offen offset:1024 sc1 lds
    s_mov_b32 exec_hi, 0
    buffer_load_dwordx4 v24, s[4:7], s26 offen offset:2048 sc1 lds
    s_mov_b32 exec_hi, -1
    s_cmp_eq_u32 s27, 27
    s_cselect_b32 s38, -266240, 0
    s_cselect_b32 s27, 0, s27
    s_cselect_b32 s38, s38, 10240
    s_add_u32 s26, s26, s38
    s_add_u32 m0, s31, 137216
    s_add_u32 s29, s29, 1
    buffer_load_dwordx4 v6, s[4:7], s28 offen offset:0 sc1 lds
    buffer_load_dwordx4 v6, s[4:7], s28 offen offset:1024 sc1 lds
    s_cmp_eq_u32 s29, 27
    s_cselect_b32 s38, -53248, 0
    s_cselect_b32 s29, 0, s29
    s_cselect_b32 s38, s38, 2048
    s_add_u32 s28, s28, s38
    s_waitcnt vmcnt(15)
    s_barrier
    s_add_u32 m0, s30, 30720
    s_add_u32 s27, s27, 1
    buffer_load_dwordx4 v24, s[4:7], s26 offen offset:0 sc1 lds
    buffer_load_dwordx4 v24, s[4:7], s26 offen offset:1024 sc1 lds
    s_mov_b32 exec_hi, 0
    buffer_load_dwordx4 v24, s[4:7], s26 offen offset:2048 sc1 lds
    s_mov_b32 exec_hi, -1
    s_cmp_eq_u32 s27, 27
    s_cselect_b32 s38, -266240, 0
    s_cselect_b32 s27, 0, s27
    s_cselect_b32 s38, s38, 10240
    s_add_u32 s26, s26, s38
    s_add_u32 m0, s31, 145408
    s_add_u32 s29, s29, 1
    buffer_load_dwordx4 v6, s[4:7], s28 offen offset:0 sc1 lds
    buffer_load_dwordx4 v6, s[4:7], s28 offen offset:1024 sc1 lds
    s_cmp_eq_u32 s29, 27
    s_cselect_b32 s38, -53248, 0
    s_cselect_b32 s29, 0, s29
    s_cselect_b32 s38, s38, 2048
    s_add_u32 s28, s28, s38
    s_waitcnt vmcnt(15)
    s_barrier
    s_add_u32 m0, s30, 40960
    s_add_u32 s27, s27, 1
    buffer_load_dwordx4 v24, s[4:7], s26 offen offset:0 sc1 lds
    buffer_load_dwordx4 v24, s[4:7], s26 offen offset:1024 sc1 lds
    s_mov_b32 exec_hi, 0
    buffer_load_dwordx4 v24, s[4:7], s26 offen offset:2048 sc1 lds
    s_mov_b32 exec_hi, -1
    s_cmp_eq_u32 s27, 27
    s_cselect_b32 s38, -266240, 0
    s_cselect_b32 s27, 0, s27
    s_cselect_b32 s38, s38, 10240
    s_add_u32 s26, s26, s38
    s_add_u32 m0, s31, 112640
    s_add_u32 s29, s29, 1
    buffer_load_dwordx4 v6, s[4:7], s28 offen offset:0 sc1 lds
    buffer_load_dwordx4 v6, s[4:7], s28 offen offset:1024 sc1 lds
    s_cmp_eq_u32 s29, 27
    s_cselect_b32 s38, -53248, 0
    s_cselect_b32 s29, 0, s29
    s_cselect_b32 s38, s38, 2048
    s_add_u32 s28, s28, s38
    s_waitcnt vmcnt(15)
    s_barrier
    s_add_u32 m0, s31, 120832
    s_add_u32 s29, s29, 1
    buffer_load_dwordx4 v6, s[4:7], s28 offen offset:0 sc1 lds
    buffer_load_dwordx4 v6, s[4:7], s28 offen offset:1024 sc1 lds
    s_cmp_eq_u32 s29, 27
    s_cselect_b32 s38, -53248, 0
    s_cselect_b32 s29, 0, s29
    s_cselect_b32 s38, s38, 2048
    s_add_u32 s28, s28, s38
    s_waitcnt vmcnt(12)
    s_barrier
    s_add_u32 m0, s31, 129024
    s_add_u32 s29, s29, 1
    buffer_load_dwordx4 v6, s[4:7], s28 offen offset:0 sc1 lds
    buffer_load_dwordx4 v6, s[4:7], s28 offen offset:1024 sc1 lds
    s_cmp_eq_u32 s29, 27
    s_cselect_b32 s38, -53248, 0
    s_cselect_b32 s29, 0, s29
    s_cselect_b32 s38, s38, 2048
    s_add_u32 s28, s28, s38
    s_waitcnt vmcnt(9)
    s_barrier
    s_add_u32 m0, s31, 137216
    s_add_u32 s29, s29, 1
    buffer_load_dwordx4 v6, s[4:7], s28 offen offset:0 sc1 lds
    buffer_load_dwordx4 v6, s[4:7], s28 offen offset:1024 sc1 lds
    s_cmp_eq_u32 s29, 27
    s_cselect_b32 s38, -53248, 0
    s_cselect_b32 s29, 0, s29
    s_cselect_b32 s38, s38, 2048
    s_add_u32 s28, s28, s38
    s_waitcnt vmcnt(6)
    s_barrier
    s_add_u32 m0, s31, 145408
    s_add_u32 s29, s29, 1
    buffer_load_dwordx4 v6, s[4:7], s28 offen offset:0 sc1 lds
    buffer_load_dwordx4 v6, s[4:7], s28 offen offset:1024 sc1 lds
    s_cmp_eq_u32 s29, 27
    s_cselect_b32 s38, -53248, 0
    s_cselect_b32 s29, 0, s29
    s_cselect_b32 s38, s38, 2048
    s_add_u32 s28, s28, s38
    s_waitcnt vmcnt(6)
    s_barrier
    s_add_u32 m0, s31, 112640
    s_add_u32 s29, s29, 1
    buffer_load_dwordx4 v6, s[4:7], s28 offen offset:0 sc1 lds
    buffer_load_dwordx4 v6, s[4:7], s28 offen offset:1024 sc1 lds
    s_cmp_eq_u32 s29, 27
    s_cselect_b32 s38, -53248, 0
    s_cselect_b32 s29, 0, s29
    s_cselect_b32 s38, s38, 2048
    s_add_u32 s28, s28, s38
    s_waitcnt vmcnt(6)
    s_barrier
    s_add_u32 m0, s31, 120832
    s_add_u32 s29, s29, 1
    buffer_load_dwordx4 v6, s[4:7], s28 offen offset:0 sc1 lds
    buffer_load_dwordx4 v6, s[4:7], s28 offen offset:1024 sc1 lds
    s_cmp_eq_u32 s29, 27
    s_cselect_b32 s38, -53248, 0
    s_cselect_b32 s29, 0, s29
    s_cselect_b32 s38, s38, 2048
    s_add_u32 s28, s28, s38
    s_waitcnt vmcnt(6)
    s_barrier
    s_waitcnt vmcnt(4)
    s_barrier
    s_waitcnt vmcnt(2)
    s_barrier
    s_waitcnt vmcnt(0)
    s_barrier
    s_barrier
    s_waitcnt vmcnt(0)
    s_endpgm
sequential_preLN__grouped_kv_mqa__dense_activation_silu__prompt_kernel_comp:
    s_waitcnt vmcnt(0)
    s_barrier
    v_lshrrev_b32 v9, 4, v1
    v_and_b32 v3, 15, v1
    v_lshrrev_b32 v2, 1, v9
    v_lshlrev_b32 v2, 8, v2
    v_lshl_add_u32 v2, v3, 4, v2
    v_and_b32 v4, 1, v9
    v_lshl_add_u32 v7, v4, 3, v2
    v_mul_u32_u24 v8, 1280, v3
    v_lshl_add_u32 v8, v9, 3, v8
    s_lshl_b32 s45, s12, 2
    s_add_u32 s45, s45, s3
    s_mul_i32 s42, s13, 5
    s_lshl_b32 s38, s42, 9
    s_mul_i32 s47, s45, 20480
    s_lshl_b32 s39, s42, 5
    s_add_u32 s47, s47, s39
    s_mul_i32 s46, s45, 20480
    s_add_u32 s46, s46, s38
    s_add_u32 s46, s46, 5767168
    s_mul_i32 s38, s3, 2048
    s_add_u32 s38, s38, 102400
    v_add_u32 v10, s38, v6
    v_add_u32 v11, 0, v6
    s_mov_b32 s30, 0
    s_mov_b32 s26, 0
    s_mov_b32 s27, 0
    s_mov_b32 s8, s78
    s_mov_b32 s9, s79
    s_mov_b32 s10, 2621440
    s_mov_b32 s11, 0x00020000
    buffer_load_dwordx2 v[30:31], v8, s[8:11], s47 offen offset:0
    buffer_load_dwordx2 v[32:33], v8, s[8:11], s47 offen offset:32
    buffer_load_dwordx2 v[34:35], v8, s[8:11], s47 offen offset:64
    buffer_load_dwordx2 v[36:37], v8, s[8:11], s47 offen offset:96
    buffer_load_dwordx2 v[38:39], v8, s[8:11], s47 offen offset:128
    v_mov_b32 v136, 0
    v_mov_b32 v137, 0
    v_mov_b32 v138, 0
    v_mov_b32 v139, 0
    v_mov_b32 v140, 0
    v_mov_b32 v141, 0
    v_mov_b32 v142, 0
    v_mov_b32 v143, 0
    v_mov_b32 v144, 0
    v_mov_b32 v145, 0
    v_mov_b32 v146, 0
    v_mov_b32 v147, 0
    v_mov_b32 v148, 0
    v_mov_b32 v149, 0
    v_mov_b32 v150, 0
    v_mov_b32 v151, 0
    v_mov_b32 v152, 0
    v_mov_b32 v153, 0
    v_mov_b32 v154, 0
    v_mov_b32 v155, 0
    s_barrier
    s_barrier
    ds_read_b128 v[60:63], v10 offset:0
    ds_read_b128 v[40:43], v11 offset:0
    ds_read_b128 v[44:47], v11 offset:1024
    ds_read_b128 v[48:51], v11 offset:2048
    ds_read_b128 v[52:55], v11 offset:3072
    ds_read_b128 v[56:59], v11 offset:4096
    ds_read_b128 v[84:87], v10 offset:1024
    ds_read_b128 v[64:67], v11 offset:5120
    ds_read_b128 v[68:71], v11 offset:6144
    ds_read_b128 v[72:75], v11 offset:7168
    ds_read_b128 v[76:79], v11 offset:8192
    ds_read_b128 v[80:83], v11 offset:9216
    s_add_u32 s26, s26, 10240
    s_cmp_eq_u32 s26, 102400
    s_cselect_b32 s28, -92160, 0
    s_cselect_b32 s26, 0, s26
    s_cselect_b32 s28, s28, 10240
    v_add_u32 v11, s28, v11
    s_add_u32 s27, s27, 8192
    s_cmp_eq_u32 s27, 40960
    s_cselect_b32 s29, -32768, 0
    s_cselect_b32 s27, 0, s27
    s_cselect_b32 s29, s29, 8192
    v_add_u32 v10, s29, v10
    s_branch sequential_preLN__grouped_kv_mqa__dense_activation_silu__prompt_kernel_C_loop
.p2alignl 6, 0xBF800000
sequential_preLN__grouped_kv_mqa__dense_activation_silu__prompt_kernel_C_loop:
    s_waitcnt lgkmcnt(0)
    s_barrier
    ds_read_b128 v[108:111], v10 offset:0
    ds_read_b128 v[88:91], v11 offset:0
    ds_read_b128 v[92:95], v11 offset:1024
    v_mfma_f32_16x16x32_bf16 v[136:139], v[40:43], v[60:63], v[136:139]
    ds_read_b128 v[96:99], v11 offset:2048
    ds_read_b128 v[100:103], v11 offset:3072
    v_mfma_f32_16x16x32_bf16 v[140:143], v[44:47], v[60:63], v[140:143]
    ds_read_b128 v[104:107], v11 offset:4096
    ds_read_b128 v[132:135], v10 offset:1024
    ds_read_b128 v[112:115], v11 offset:5120
    v_mfma_f32_16x16x32_bf16 v[144:147], v[48:51], v[60:63], v[144:147]
    ds_read_b128 v[116:119], v11 offset:6144
    ds_read_b128 v[120:123], v11 offset:7168
    v_mfma_f32_16x16x32_bf16 v[148:151], v[52:55], v[60:63], v[148:151]
    ds_read_b128 v[124:127], v11 offset:8192
    ds_read_b128 v[128:131], v11 offset:9216
    v_mfma_f32_16x16x32_bf16 v[152:155], v[56:59], v[60:63], v[152:155]
    v_mfma_f32_16x16x32_bf16 v[136:139], v[64:67], v[84:87], v[136:139]
    s_add_u32 s26, s26, 10240
    s_cmp_eq_u32 s26, 102400
    s_cselect_b32 s28, -92160, 0
    s_cselect_b32 s26, 0, s26
    v_mfma_f32_16x16x32_bf16 v[140:143], v[68:71], v[84:87], v[140:143]
    s_cselect_b32 s28, s28, 10240
    v_add_u32 v11, s28, v11
    s_add_u32 s27, s27, 8192
    s_cmp_eq_u32 s27, 40960
    v_mfma_f32_16x16x32_bf16 v[144:147], v[72:75], v[84:87], v[144:147]
    s_cselect_b32 s29, -32768, 0
    s_cselect_b32 s27, 0, s27
    s_cselect_b32 s29, s29, 8192
    v_add_u32 v10, s29, v10
    v_mfma_f32_16x16x32_bf16 v[148:151], v[76:79], v[84:87], v[148:151]
    s_add_u32 s30, s30, 1
    s_cmp_lt_u32 s30, 10
    v_mfma_f32_16x16x32_bf16 v[152:155], v[80:83], v[84:87], v[152:155]
    s_cbranch_scc0 sequential_preLN__grouped_kv_mqa__dense_activation_silu__prompt_kernel_C_ldone
    s_waitcnt lgkmcnt(0)
    s_barrier
    ds_read_b128 v[60:63], v10 offset:0
    ds_read_b128 v[40:43], v11 offset:0
    ds_read_b128 v[44:47], v11 offset:1024
    v_mfma_f32_16x16x32_bf16 v[136:139], v[88:91], v[108:111], v[136:139]
    ds_read_b128 v[48:51], v11 offset:2048
    ds_read_b128 v[52:55], v11 offset:3072
    v_mfma_f32_16x16x32_bf16 v[140:143], v[92:95], v[108:111], v[140:143]
    ds_read_b128 v[56:59], v11 offset:4096
    ds_read_b128 v[84:87], v10 offset:1024
    ds_read_b128 v[64:67], v11 offset:5120
    v_mfma_f32_16x16x32_bf16 v[144:147], v[96:99], v[108:111], v[144:147]
    ds_read_b128 v[68:71], v11 offset:6144
    ds_read_b128 v[72:75], v11 offset:7168
    v_mfma_f32_16x16x32_bf16 v[148:151], v[100:103], v[108:111], v[148:151]
    ds_read_b128 v[76:79], v11 offset:8192
    ds_read_b128 v[80:83], v11 offset:9216
    v_mfma_f32_16x16x32_bf16 v[152:155], v[104:107], v[108:111], v[152:155]
    v_mfma_f32_16x16x32_bf16 v[136:139], v[112:115], v[132:135], v[136:139]
    s_add_u32 s26, s26, 10240
    s_cmp_eq_u32 s26, 102400
    s_cselect_b32 s28, -92160, 0
    s_cselect_b32 s26, 0, s26
    v_mfma_f32_16x16x32_bf16 v[140:143], v[116:119], v[132:135], v[140:143]
    s_cselect_b32 s28, s28, 10240
    v_add_u32 v11, s28, v11
    s_add_u32 s27, s27, 8192
    s_cmp_eq_u32 s27, 40960
    v_mfma_f32_16x16x32_bf16 v[144:147], v[120:123], v[132:135], v[144:147]
    s_cselect_b32 s29, -32768, 0
    s_cselect_b32 s27, 0, s27
    s_cselect_b32 s29, s29, 8192
    v_add_u32 v10, s29, v10
    v_mfma_f32_16x16x32_bf16 v[148:151], v[124:127], v[132:135], v[148:151]
    s_add_u32 s30, s30, 1
    s_cmp_lt_u32 s30, 10
    v_mfma_f32_16x16x32_bf16 v[152:155], v[128:131], v[132:135], v[152:155]
    s_cbranch_scc1 sequential_preLN__grouped_kv_mqa__dense_activation_silu__prompt_kernel_C_loop
sequential_preLN__grouped_kv_mqa__dense_activation_silu__prompt_kernel_C_ldone:
    s_waitcnt vmcnt(0) lgkmcnt(0)
    s_nop 4
    v_and_b32 v2, 15, v1
    v_and_b32 v5, 1, v9
    v_lshrrev_b32 v76, 1, v9
    v_lshlrev_b32 v3, 4, v2
    v_lshl_add_u32 v3, v5, 9, v3
    v_lshl_add_u32 v3, v76, 8, v3
    v_mov_b32 v72, 0
    v_mov_b32 v73, 0
    v_lshlrev_b32 v76, 16, v38
    v_and_b32 v77, 0xffff0000, v38
    v_pk_add_f32 v[152:153], v[152:153], v[76:77]
    v_lshlrev_b32 v76, 16, v39
    v_and_b32 v77, 0xffff0000, v39
    v_pk_add_f32 v[154:155], v[154:155], v[76:77]
    v_cvt_pk_bf16_f32 v88, v152, v153
    v_cvt_pk_bf16_f32 v89, v154, v155
    v_mov_b32 v38, v88
    v_mov_b32 v39, v89
    buffer_store_dwordx2 v[88:89], v7, s[4:7], s46 offen offset:2048 sc1
    v_lshlrev_b32 v76, 16, v30
    v_and_b32 v77, 0xffff0000, v30
    v_pk_add_f32 v[136:137], v[136:137], v[76:77]
    v_lshlrev_b32 v76, 16, v31
    v_and_b32 v77, 0xffff0000, v31
    v_pk_add_f32 v[138:139], v[138:139], v[76:77]
    v_cvt_pk_bf16_f32 v80, v136, v137
    v_cvt_pk_bf16_f32 v81, v138, v139
    v_mov_b32 v30, v80
    v_mov_b32 v31, v81
    v_lshlrev_b32 v76, 16, v32
    v_and_b32 v77, 0xffff0000, v32
    v_pk_add_f32 v[140:141], v[140:141], v[76:77]
    v_lshlrev_b32 v76, 16, v33
    v_and_b32 v77, 0xffff0000, v33
    v_pk_add_f32 v[142:143], v[142:143], v[76:77]
    v_cvt_pk_bf16_f32 v82, v140, v141
    v_cvt_pk_bf16_f32 v83, v142, v143
    v_mov_b32 v32, v82
    v_mov_b32 v33, v83
    s_nop 1
    v_permlane16_swap_b32 v80, v82
    v_permlane16_swap_b32 v81, v83
    buffer_store_dwordx4 v[80:83], v3, s[4:7], s46 offen offset:0 sc1
    v_lshlrev_b32 v76, 16, v34
    v_and_b32 v77, 0xffff0000, v34
    v_pk_add_f32 v[144:145], v[144:145], v[76:77]
    v_lshlrev_b32 v76, 16, v35
    v_and_b32 v77, 0xffff0000, v35
    v_pk_add_f32 v[146:147], v[146:147], v[76:77]
    v_cvt_pk_bf16_f32 v84, v144, v145
    v_cvt_pk_bf16_f32 v85, v146, v147
    v_mov_b32 v34, v84
    v_mov_b32 v35, v85
    v_lshlrev_b32 v76, 16, v36
    v_and_b32 v77, 0xffff0000, v36
    v_pk_add_f32 v[148:149], v[148:149], v[76:77]
    v_lshlrev_b32 v76, 16, v37
    v_and_b32 v77, 0xffff0000, v37
    v_pk_add_f32 v[150:151], v[150:151], v[76:77]
    v_cvt_pk_bf16_f32 v86, v148, v149
    v_cvt_pk_bf16_f32 v87, v150, v151
    v_mov_b32 v36, v86
    v_mov_b32 v37, v87
    s_nop 1
    v_permlane16_swap_b32 v84, v86
    v_permlane16_swap_b32 v85, v87
    buffer_store_dwordx4 v[84:87], v3, s[4:7], s46 offen offset:1024 sc1
    v_lshlrev_b32 v76, 16, v30
    v_and_b32 v77, 0xffff0000, v30
    v_add_f32 v72, v72, v76
    v_fmac_f32 v73, v76, v76
    v_add_f32 v72, v72, v77
    v_fmac_f32 v73, v77, v77
    v_lshlrev_b32 v76, 16, v31
    v_and_b32 v77, 0xffff0000, v31
    v_add_f32 v72, v72, v76
    v_fmac_f32 v73, v76, v76
    v_add_f32 v72, v72, v77
    v_fmac_f32 v73, v77, v77
    v_lshlrev_b32 v76, 16, v32
    v_and_b32 v77, 0xffff0000, v32
    v_add_f32 v72, v72, v76
    v_fmac_f32 v73, v76, v76
    v_add_f32 v72, v72, v77
    v_fmac_f32 v73, v77, v77
    v_lshlrev_b32 v76, 16, v33
    v_and_b32 v77, 0xffff0000, v33
    v_add_f32 v72, v72, v76
    v_fmac_f32 v73, v76, v76
    v_add_f32 v72, v72, v77
    v_fmac_f32 v73, v77, v77
    v_lshlrev_b32 v76, 16, v34
    v_and_b32 v77, 0xffff0000, v34
    v_add_f32 v72, v72, v76
    v_fmac_f32 v73, v76, v76
    v_add_f32 v72, v72, v77
    v_fmac_f32 v73, v77, v77
    v_lshlrev_b32 v76, 16, v35
    v_and_b32 v77, 0xffff0000, v35
    v_add_f32 v72, v72, v76
    v_fmac_f32 v73, v76, v76
    v_add_f32 v72, v72, v77
    v_fmac_f32 v73, v77, v77
    v_lshlrev_b32 v76, 16, v36
    v_and_b32 v77, 0xffff0000, v36
    v_add_f32 v72, v72, v76
    v_fmac_f32 v73, v76, v76
    v_add_f32 v72, v72, v77
    v_fmac_f32 v73, v77, v77
    v_lshlrev_b32 v76, 16, v37
    v_and_b32 v77, 0xffff0000, v37
    v_add_f32 v72, v72, v76
    v_fmac_f32 v73, v76, v76
    v_add_f32 v72, v72, v77
    v_fmac_f32 v73, v77, v77
    v_lshlrev_b32 v76, 16, v38
    v_and_b32 v77, 0xffff0000, v38
    v_add_f32 v72, v72, v76
    v_fmac_f32 v73, v76, v76
    v_add_f32 v72, v72, v77
    v_fmac_f32 v73, v77, v77
    v_lshlrev_b32 v76, 16, v39
    v_and_b32 v77, 0xffff0000, v39
    v_add_f32 v72, v72, v76
    v_fmac_f32 v73, v76, v76
    v_add_f32 v72, v72, v77
    v_fmac_f32 v73, v77, v77
    v_mov_b32 v76, v72
    s_nop 1
    v_permlane16_swap_b32 v72, v76
    s_nop 1
    v_add_f32 v72, v72, v76
    v_mov_b32 v76, v72
    s_nop 1
    v_permlane32_swap_b32 v72, v76
    s_nop 1
    v_add_f32 v72, v72, v76
    v_mov_b32 v76, v73
    s_nop 1
    v_permlane16_swap_b32 v73, v76
    s_nop 1
    v_add_f32 v73, v73, v76
    v_mov_b32 v76, v73
    s_nop 1
    v_permlane32_swap_b32 v73, v76
    s_nop 1
    v_add_f32 v73, v73, v76
    v_lshlrev_b32 v2, 3, v1
    s_lshl_b32 s38, s45, 7
    s_lshl_b32 s39, s13, 14
    s_add_u32 s38, s38, s39
    s_add_u32 s38, s38, 2883584
    s_mov_b64 exec, 0xffff
    buffer_store_dwordx2 v[72:73], v2, s[4:7], s38 offen sc1
    s_mov_b64 exec, -1
    s_waitcnt vmcnt(0)
    s_barrier
    s_lshl_b32 s45, s15, 2
    s_add_u32 s45, s45, s62
    s_lshl_b32 s45, s45, 1
    s_mul_i32 s42, s16, 7
    s_sub_i32 s40, s16, 12
    s_max_i32 s40, s40, 0
    s_sub_u32 s42, s42, s40
    s_cmp_ge_u32 s16, 12
    s_cselect_b32 s43, 6, 7
    s_lshl_b32 s38, s42, 9
    s_mul_i32 s46, s45, 55296
    s_add_u32 s46, s46, s38
    s_add_u32 s46, s46, 8388608
    s_mul_i32 s38, s3, 4096
    s_add_u32 s38, s38, 86016
    v_add_u32 v10, s38, v6
    v_add_u32 v11, 28672, v6
    s_mov_b32 s30, 0
    s_mov_b32 s26, 28672
    s_mov_b32 s27, 0
    v_mov_b32 v112, 0
    v_mov_b32 v113, 0
    v_mov_b32 v114, 0
    v_mov_b32 v115, 0
    v_mov_b32 v116, 0
    v_mov_b32 v117, 0
    v_mov_b32 v118, 0
    v_mov_b32 v119, 0
    v_mov_b32 v120, 0
    v_mov_b32 v121, 0
    v_mov_b32 v122, 0
    v_mov_b32 v123, 0
    v_mov_b32 v124, 0
    v_mov_b32 v125, 0
    v_mov_b32 v126, 0
    v_mov_b32 v127, 0
    v_mov_b32 v128, 0
    v_mov_b32 v129, 0
    v_mov_b32 v130, 0
    v_mov_b32 v131, 0
    v_mov_b32 v132, 0
    v_mov_b32 v133, 0
    v_mov_b32 v134, 0
    v_mov_b32 v135, 0
    v_mov_b32 v136, 0
    v_mov_b32 v137, 0
    v_mov_b32 v138, 0
    v_mov_b32 v139, 0
    v_mov_b32 v140, 0
    v_mov_b32 v141, 0
    v_mov_b32 v142, 0
    v_mov_b32 v143, 0
    v_mov_b32 v144, 0
    v_mov_b32 v145, 0
    v_mov_b32 v146, 0
    v_mov_b32 v147, 0
    v_mov_b32 v148, 0
    v_mov_b32 v149, 0
    v_mov_b32 v150, 0
    v_mov_b32 v151, 0
    v_mov_b32 v152, 0
    v_mov_b32 v153, 0
    v_mov_b32 v154, 0
    v_mov_b32 v155, 0
    v_mov_b32 v156, 0
    v_mov_b32 v157, 0
    v_mov_b32 v158, 0
    v_mov_b32 v159, 0
    v_mov_b32 v160, 0
    v_mov_b32 v161, 0
    v_mov_b32 v162, 0
    v_mov_b32 v163, 0
    v_mov_b32 v164, 0
    v_mov_b32 v165, 0
    v_mov_b32 v166, 0
    v_mov_b32 v167, 0
    s_barrier
    v_and_b32 v3, 15, v1
    v_lshlrev_b32 v2, 3, v3
    v_lshl_add_u32 v2, v9, 15, v2
    v_add_u32 v3, 16384, v2
    s_lshl_b32 s38, s45, 7
    s_add_u32 s38, s38, 2883584
    buffer_load_dwordx2 v[30:31], v2, s[4:7], s38 offen sc1
    buffer_load_dwordx2 v[32:33], v3, s[4:7], s38 offen sc1
    s_barrier
    ds_read_b128 v[68:71], v10 offset:0
    ds_read_b128 v[72:75], v10 offset:2048
    ds_read_b128 v[40:43], v11 offset:0
    ds_read_b128 v[44:47], v11 offset:1024
    ds_read_b128 v[48:51], v11 offset:2048
    ds_read_b128 v[52:55], v11 offset:3072
    ds_read_b128 v[56:59], v11 offset:4096
    ds_read_b128 v[60:63], v11 offset:5120
    ds_read_b128 v[64:67], v11 offset:6144
    s_branch sequential_preLN__grouped_kv_mqa__dense_activation_silu__prompt_kernel_D_loop
.p2alignl 6, 0xBF800000
sequential_preLN__grouped_kv_mqa__dense_activation_silu__prompt_kernel_D_loop:
    s_waitcnt lgkmcnt(0)
    ds_read_b128 v[104:107], v10 offset:1024
    ds_read_b128 v[108:111], v10 offset:3072
    v_mfma_f32_16x16x32_bf16 v[112:115], v[40:43], v[68:71], v[112:115]
    ds_read_b128 v[76:79], v11 offset:7168
    ds_read_b128 v[80:83], v11 offset:8192
    v_mfma_f32_16x16x32_bf16 v[140:143], v[40:43], v[72:75], v[140:143]
    ds_read_b128 v[84:87], v11 offset:9216
    ds_read_b128 v[88:91], v11 offset:10240
    v_mfma_f32_16x16x32_bf16 v[116:119], v[44:47], v[68:71], v[116:119]
    ds_read_b128 v[92:95], v11 offset:11264
    ds_read_b128 v[96:99], v11 offset:12288
    v_mfma_f32_16x16x32_bf16 v[144:147], v[44:47], v[72:75], v[144:147]
    ds_read_b128 v[100:103], v11 offset:13312
    v_mfma_f32_16x16x32_bf16 v[120:123], v[48:51], v[68:71], v[120:123]
    v_mfma_f32_16x16x32_bf16 v[148:151], v[48:51], v[72:75], v[148:151]
    s_add_u32 s26, s26, 14336
    s_cmp_eq_u32 s26, 86016
    v_mfma_f32_16x16x32_bf16 v[124:127], v[52:55], v[68:71], v[124:127]
    s_cselect_b32 s28, -71680, 0
    s_cselect_b32 s26, 0, s26
    v_mfma_f32_16x16x32_bf16 v[152:155], v[52:55], v[72:75], v[152:155]
    s_cselect_b32 s28, s28, 14336
    v_add_u32 v11, s28, v11
    v_mfma_f32_16x16x32_bf16 v[128:131], v[56:59], v[68:71], v[128:131]
    s_add_u32 s27, s27, 16384
    s_cmp_eq_u32 s27, 65536
    v_mfma_f32_16x16x32_bf16 v[156:159], v[56:59], v[72:75], v[156:159]
    s_cselect_b32 s29, -49152, 0
    s_cselect_b32 s27, 0, s27
    v_mfma_f32_16x16x32_bf16 v[132:135], v[60:63], v[68:71], v[132:135]
    s_cselect_b32 s29, s29, 16384
    v_add_u32 v10, s29, v10
    v_mfma_f32_16x16x32_bf16 v[160:163], v[60:63], v[72:75], v[160:163]
    v_mfma_f32_16x16x32_bf16 v[136:139], v[64:67], v[68:71], v[136:139]
    v_mfma_f32_16x16x32_bf16 v[164:167], v[64:67], v[72:75], v[164:167]
    s_waitcnt lgkmcnt(0)
    s_barrier
    ds_read_b128 v[68:71], v10 offset:0
    ds_read_b128 v[72:75], v10 offset:2048
    v_mfma_f32_16x16x32_bf16 v[112:115], v[76:79], v[104:107], v[112:115]
    ds_read_b128 v[40:43], v11 offset:0
    ds_read_b128 v[44:47], v11 offset:1024
    v_mfma_f32_16x16x32_bf16 v[140:143], v[76:79], v[108:111], v[140:143]
    ds_read_b128 v[48:51], v11 offset:2048
    ds_read_b128 v[52:55], v11 offset:3072
    v_mfma_f32_16x16x32_bf16 v[116:119], v[80:83], v[104:107], v[116:119]
    ds_read_b128 v[56:59], v11 offset:4096
    ds_read_b128 v[60:63], v11 offset:5120
    v_mfma_f32_16x16x32_bf16 v[144:147], v[80:83], v[108:111], v[144:147]
    ds_read_b128 v[64:67], v11 offset:6144
    v_mfma_f32_16x16x32_bf16 v[120:123], v[84:87], v[104:107], v[120:123]
    v_mfma_f32_16x16x32_bf16 v[148:151], v[84:87], v[108:111], v[148:151]
    s_add_u32 s30, s30, 1
    v_mfma_f32_16x16x32_bf16 v[124:127], v[88:91], v[104:107], v[124:127]
    s_cmp_lt_u32 s30, 10
    v_mfma_f32_16x16x32_bf16 v[152:155], v[88:91], v[108:111], v[152:155]
    v_mfma_f32_16x16x32_bf16 v[128:131], v[92:95], v[104:107], v[128:131]
    v_mfma_f32_16x16x32_bf16 v[156:159], v[92:95], v[108:111], v[156:159]
    v_mfma_f32_16x16x32_bf16 v[132:135], v[96:99], v[104:107], v[132:135]
    v_mfma_f32_16x16x32_bf16 v[160:163], v[96:99], v[108:111], v[160:163]
    v_mfma_f32_16x16x32_bf16 v[136:139], v[100:103], v[104:107], v[136:139]
    v_mfma_f32_16x16x32_bf16 v[164:167], v[100:103], v[108:111], v[164:167]
    s_cbranch_scc1 sequential_preLN__grouped_kv_mqa__dense_activation_silu__prompt_kernel_D_loop
    s_mul_i32 s38, s62, 7168
    s_add_u32 s38, s38, 112640
    v_add_u32 v2, s38, v6
    s_waitcnt vmcnt(0) lgkmcnt(0)
    s_nop 4
    ds_write_b128 v2, v[140:143] offset:0
    ds_write_b128 v2, v[144:147] offset:1024
    ds_write_b128 v2, v[148:151] offset:2048
    ds_write_b128 v2, v[152:155] offset:3072
    ds_write_b128 v2, v[156:159] offset:4096
    ds_write_b128 v2, v[160:163] offset:5120
    ds_write_b128 v2, v[164:167] offset:6144
    s_waitcnt lgkmcnt(0)
    s_barrier
    v_lshlrev_b32 v2, 4, v9
    v_add_u32 v2, 153600, v2
    ds_read_b128 v[40:43], v2 offset:0
    ds_read_b128 v[44:47], v2 offset:64
    ds_read_b128 v[48:51], v2 offset:128
    ds_read_b128 v[52:55], v2 offset:192
    ds_read_b128 v[56:59], v2 offset:256
    ds_read_b128 v[60:63], v2 offset:320
    ds_read_b128 v[64:67], v2 offset:384
    v_add_f32 v30, v30, v32
    v_add_f32 v31, v31, v33
    v_mov_b32 v12, v30
    s_nop 1
    v_permlane16_swap_b32 v30, v12
    s_nop 1
    v_add_f32 v30, v30, v12
    v_mov_b32 v12, v30
    s_nop 1
    v_permlane32_swap_b32 v30, v12
    s_nop 1
    v_add_f32 v30, v30, v12
    v_mov_b32 v12, v31
    s_nop 1
    v_permlane16_swap_b32 v31, v12
    s_nop 1
    v_add_f32 v31, v31, v12
    v_mov_b32 v12, v31
    s_nop 1
    v_permlane32_swap_b32 v31, v12
    s_nop 1
    v_add_f32 v31, v31, v12
    v_mul_f32 v30, 0xbacccccd, v30
    v_mul_f32 v12, 0x3acccccd, v31
    v_fma_f32 v12, -v30, v30, v12
    v_max_f32 v12, 0, v12
    v_add_f32 v12, 0x3727c5ac, v12
    v_rsq_f32 v31, v12
    v_and_b32 v2, 15, v1
    v_mul_f32 v32, 0xbfb8aa3b, v31
    v_and_b32 v5, 1, v9
    v_lshrrev_b32 v4, 1, v9
    v_lshlrev_b32 v3, 4, v2
    v_lshl_add_u32 v3, v4, 8, v3
    v_lshl_add_u32 v4, v5, 3, v3
    v_lshl_add_u32 v3, v5, 9, v3
    s_waitcnt lgkmcnt(0)
    v_pk_fma_f32 v[112:113], v[40:41], v[30:31], v[112:113] op_sel_hi:[1,0,1]
    v_pk_fma_f32 v[114:115], v[42:43], v[30:31], v[114:115] op_sel_hi:[1,0,1]
    v_pk_mul_f32 v[12:13], v[112:113], v[32:33] op_sel_hi:[1,0]
    v_pk_mul_f32 v[14:15], v[114:115], v[32:33] op_sel_hi:[1,0]
    v_exp_f32 v12, v12
    v_exp_f32 v13, v13
    v_exp_f32 v14, v14
    v_exp_f32 v15, v15
    v_pk_mul_f32 v[112:113], v[112:113], v[30:31] op_sel:[0,1] op_sel_hi:[1,1]
    v_pk_mul_f32 v[114:115], v[114:115], v[30:31] op_sel:[0,1] op_sel_hi:[1,1]
    v_pk_fma_f32 v[116:117], v[44:45], v[30:31], v[116:117] op_sel_hi:[1,0,1]
    v_pk_fma_f32 v[118:119], v[46:47], v[30:31], v[118:119] op_sel_hi:[1,0,1]
    v_pk_mul_f32 v[16:17], v[116:117], v[32:33] op_sel_hi:[1,0]
    v_pk_mul_f32 v[18:19], v[118:119], v[32:33] op_sel_hi:[1,0]
    v_exp_f32 v16, v16
    v_exp_f32 v17, v17
    v_exp_f32 v18, v18
    v_exp_f32 v19, v19
    v_pk_mul_f32 v[116:117], v[116:117], v[30:31] op_sel:[0,1] op_sel_hi:[1,1]
    v_pk_mul_f32 v[118:119], v[118:119], v[30:31] op_sel:[0,1] op_sel_hi:[1,1]
    v_pk_add_f32 v[12:13], v[12:13], 1.0 op_sel_hi:[1,0]
    v_pk_add_f32 v[14:15], v[14:15], 1.0 op_sel_hi:[1,0]
    v_rcp_f32 v12, v12
    v_rcp_f32 v13, v13
    v_rcp_f32 v14, v14
    v_rcp_f32 v15, v15
    v_pk_add_f32 v[16:17], v[16:17], 1.0 op_sel_hi:[1,0]
    v_pk_add_f32 v[18:19], v[18:19], 1.0 op_sel_hi:[1,0]
    v_rcp_f32 v16, v16
    v_rcp_f32 v17, v17
    v_rcp_f32 v18, v18
    v_rcp_f32 v19, v19
    v_pk_mul_f32 v[112:113], v[112:113], v[12:13]
    v_pk_mul_f32 v[114:115], v[114:115], v[14:15]
    v_cvt_pk_bf16_f32 v72, v112, v113
    v_cvt_pk_bf16_f32 v73, v114, v115
    v_pk_mul_f32 v[116:117], v[116:117], v[16:17]
    v_pk_mul_f32 v[118:119], v[118:119], v[18:19]
    v_cvt_pk_bf16_f32 v74, v116, v117
    v_cvt_pk_bf16_f32 v75, v118, v119
    s_nop 1
    v_permlane16_swap_b32 v72, v74
    v_permlane16_swap_b32 v73, v75
    buffer_store_dwordx4 v[72:75], v3, s[4:7], s46 offen offset:0 sc1
    v_pk_fma_f32 v[120:121], v[48:49], v[30:31], v[120:121] op_sel_hi:[1,0,1]
    v_pk_fma_f32 v[122:123], v[50:51], v[30:31], v[122:123] op_sel_hi:[1,0,1]
    v_pk_mul_f32 v[12:13], v[120:121], v[32:33] op_sel_hi:[1,0]
    v_pk_mul_f32 v[14:15], v[122:123], v[32:33] op_sel_hi:[1,0]
    v_exp_f32 v12, v12
    v_exp_f32 v13, v13
    v_exp_f32 v14, v14
    v_exp_f32 v15, v15
    v_pk_mul_f32 v[120:121], v[120:121], v[30:31] op_sel:[0,1] op_sel_hi:[1,1]
    v_pk_mul_f32 v[122:123], v[122:123], v[30:31] op_sel:[0,1] op_sel_hi:[1,1]
    v_pk_fma_f32 v[124:125], v[52:53], v[30:31], v[124:125] op_sel_hi:[1,0,1]
    v_pk_fma_f32 v[126:127], v[54:55], v[30:31], v[126:127] op_sel_hi:[1,0,1]
    v_pk_mul_f32 v[16:17], v[124:125], v[32:33] op_sel_hi:[1,0]
    v_pk_mul_f32 v[18:19], v[126:127], v[32:33] op_sel_hi:[1,0]
    v_exp_f32 v16, v16
    v_exp_f32 v17, v17
    v_exp_f32 v18, v18
    v_exp_f32 v19, v19
    v_pk_mul_f32 v[124:125], v[124:125], v[30:31] op_sel:[0,1] op_sel_hi:[1,1]
    v_pk_mul_f32 v[126:127], v[126:127], v[30:31] op_sel:[0,1] op_sel_hi:[1,1]
    v_pk_add_f32 v[12:13], v[12:13], 1.0 op_sel_hi:[1,0]
    v_pk_add_f32 v[14:15], v[14:15], 1.0 op_sel_hi:[1,0]
    v_rcp_f32 v12, v12
    v_rcp_f32 v13, v13
    v_rcp_f32 v14, v14
    v_rcp_f32 v15, v15
    v_pk_add_f32 v[16:17], v[16:17], 1.0 op_sel_hi:[1,0]
    v_pk_add_f32 v[18:19], v[18:19], 1.0 op_sel_hi:[1,0]
    v_rcp_f32 v16, v16
    v_rcp_f32 v17, v17
    v_rcp_f32 v18, v18
    v_rcp_f32 v19, v19
    v_pk_mul_f32 v[120:121], v[120:121], v[12:13]
    v_pk_mul_f32 v[122:123], v[122:123], v[14:15]
    v_cvt_pk_bf16_f32 v76, v120, v121
    v_cvt_pk_bf16_f32 v77, v122, v123
    v_pk_mul_f32 v[124:125], v[124:125], v[16:17]
    v_pk_mul_f32 v[126:127], v[126:127], v[18:19]
    v_cvt_pk_bf16_f32 v78, v124, v125
    v_cvt_pk_bf16_f32 v79, v126, v127
    s_nop 1
    v_permlane16_swap_b32 v76, v78
    v_permlane16_swap_b32 v77, v79
    buffer_store_dwordx4 v[76:79], v3, s[4:7], s46 offen offset:1024 sc1
    v_pk_fma_f32 v[128:129], v[56:57], v[30:31], v[128:129] op_sel_hi:[1,0,1]
    v_pk_fma_f32 v[130:131], v[58:59], v[30:31], v[130:131] op_sel_hi:[1,0,1]
    v_pk_mul_f32 v[12:13], v[128:129], v[32:33] op_sel_hi:[1,0]
    v_pk_mul_f32 v[14:15], v[130:131], v[32:33] op_sel_hi:[1,0]
    v_exp_f32 v12, v12
    v_exp_f32 v13, v13
    v_exp_f32 v14, v14
    v_exp_f32 v15, v15
    v_pk_mul_f32 v[128:129], v[128:129], v[30:31] op_sel:[0,1] op_sel_hi:[1,1]
    v_pk_mul_f32 v[130:131], v[130:131], v[30:31] op_sel:[0,1] op_sel_hi:[1,1]
    v_pk_fma_f32 v[132:133], v[60:61], v[30:31], v[132:133] op_sel_hi:[1,0,1]
    v_pk_fma_f32 v[134:135], v[62:63], v[30:31], v[134:135] op_sel_hi:[1,0,1]
    v_pk_mul_f32 v[16:17], v[132:133], v[32:33] op_sel_hi:[1,0]
    v_pk_mul_f32 v[18:19], v[134:135], v[32:33] op_sel_hi:[1,0]
    v_exp_f32 v16, v16
    v_exp_f32 v17, v17
    v_exp_f32 v18, v18
    v_exp_f32 v19, v19
    v_pk_mul_f32 v[132:133], v[132:133], v[30:31] op_sel:[0,1] op_sel_hi:[1,1]
    v_pk_mul_f32 v[134:135], v[134:135], v[30:31] op_sel:[0,1] op_sel_hi:[1,1]
    v_pk_add_f32 v[12:13], v[12:13], 1.0 op_sel_hi:[1,0]
    v_pk_add_f32 v[14:15], v[14:15], 1.0 op_sel_hi:[1,0]
    v_rcp_f32 v12, v12
    v_rcp_f32 v13, v13
    v_rcp_f32 v14, v14
    v_rcp_f32 v15, v15
    v_pk_add_f32 v[16:17], v[16:17], 1.0 op_sel_hi:[1,0]
    v_pk_add_f32 v[18:19], v[18:19], 1.0 op_sel_hi:[1,0]
    v_rcp_f32 v16, v16
    v_rcp_f32 v17, v17
    v_rcp_f32 v18, v18
    v_rcp_f32 v19, v19
    v_pk_mul_f32 v[128:129], v[128:129], v[12:13]
    v_pk_mul_f32 v[130:131], v[130:131], v[14:15]
    v_cvt_pk_bf16_f32 v80, v128, v129
    v_cvt_pk_bf16_f32 v81, v130, v131
    v_pk_mul_f32 v[132:133], v[132:133], v[16:17]
    v_pk_mul_f32 v[134:135], v[134:135], v[18:19]
    v_cvt_pk_bf16_f32 v82, v132, v133
    v_cvt_pk_bf16_f32 v83, v134, v135
    s_nop 1
    v_permlane16_swap_b32 v80, v82
    v_permlane16_swap_b32 v81, v83
    buffer_store_dwordx4 v[80:83], v3, s[4:7], s46 offen offset:2048 sc1
    s_cmp_lt_u32 s43, 7
    s_cbranch_scc1 sequential_preLN__grouped_kv_mqa__dense_activation_silu__prompt_kernel_Dc_sk
    v_pk_fma_f32 v[136:137], v[64:65], v[30:31], v[136:137] op_sel_hi:[1,0,1]
    v_pk_fma_f32 v[138:139], v[66:67], v[30:31], v[138:139] op_sel_hi:[1,0,1]
    v_pk_mul_f32 v[12:13], v[136:137], v[32:33] op_sel_hi:[1,0]
    v_pk_mul_f32 v[14:15], v[138:139], v[32:33] op_sel_hi:[1,0]
    v_exp_f32 v12, v12
    v_exp_f32 v13, v13
    v_exp_f32 v14, v14
    v_exp_f32 v15, v15
    v_pk_mul_f32 v[136:137], v[136:137], v[30:31] op_sel:[0,1] op_sel_hi:[1,1]
    v_pk_mul_f32 v[138:139], v[138:139], v[30:31] op_sel:[0,1] op_sel_hi:[1,1]
    v_pk_add_f32 v[12:13], v[12:13], 1.0 op_sel_hi:[1,0]
    v_pk_add_f32 v[14:15], v[14:15], 1.0 op_sel_hi:[1,0]
    v_rcp_f32 v12, v12
    v_rcp_f32 v13, v13
    v_rcp_f32 v14, v14
    v_rcp_f32 v15, v15
    s_nop 0
    v_pk_mul_f32 v[136:137], v[136:137], v[12:13]
    v_pk_mul_f32 v[138:139], v[138:139], v[14:15]
    v_cvt_pk_bf16_f32 v84, v136, v137
    v_cvt_pk_bf16_f32 v85, v138, v139
    buffer_store_dwordx2 v[84:85], v4, s[4:7], s46 offen offset:3072 sc1
sequential_preLN__grouped_kv_mqa__dense_activation_silu__prompt_kernel_Dc_sk:
    s_waitcnt vmcnt(0)
    s_barrier
    s_lshl_b32 s45, s18, 2
    s_add_u32 s45, s45, s3
    s_mul_i32 s42, s19, 5
    s_lshl_b32 s38, s42, 9
    s_mul_i32 s47, s45, 20480
    s_lshl_b32 s39, s42, 5
    s_add_u32 s47, s47, s39
    s_mul_i32 s46, s45, 20480
    s_add_u32 s46, s46, s38
    s_add_u32 s46, s46, 5767168
    s_mul_i32 s38, s3, 2048
    s_add_u32 s38, s38, 112640
    v_add_u32 v10, s38, v6
    v_add_u32 v11, 0, v6
    s_mov_b32 s30, 0
    s_mov_b32 s26, 0
    s_mov_b32 s27, 0
    s_mov_b32 s8, s80
    s_mov_b32 s9, s81
    s_mov_b32 s10, 2621440
    s_mov_b32 s11, 0x00020000
    v_mov_b32 v136, 0
    v_mov_b32 v137, 0
    v_mov_b32 v138, 0
    v_mov_b32 v139, 0
    v_mov_b32 v140, 0
    v_mov_b32 v141, 0
    v_mov_b32 v142, 0
    v_mov_b32 v143, 0
    v_mov_b32 v144, 0
    v_mov_b32 v145, 0
    v_mov_b32 v146, 0
    v_mov_b32 v147, 0
    v_mov_b32 v148, 0
    v_mov_b32 v149, 0
    v_mov_b32 v150, 0
    v_mov_b32 v151, 0
    v_mov_b32 v152, 0
    v_mov_b32 v153, 0
    v_mov_b32 v154, 0
    v_mov_b32 v155, 0
    s_barrier
    buffer_load_dwordx2 v[30:31], v7, s[4:7], s46 offen offset:0 sc1
    buffer_load_dwordx2 v[32:33], v7, s[4:7], s46 offen offset:512 sc1
    buffer_load_dwordx2 v[34:35], v7, s[4:7], s46 offen offset:1024 sc1
    buffer_load_dwordx2 v[36:37], v7, s[4:7], s46 offen offset:1536 sc1
    buffer_load_dwordx2 v[38:39], v7, s[4:7], s46 offen offset:2048 sc1
    s_barrier
    ds_read_b128 v[60:63], v10 offset:0
    ds_read_b128 v[40:43], v11 offset:0
    ds_read_b128 v[44:47], v11 offset:1024
    ds_read_b128 v[48:51], v11 offset:2048
    ds_read_b128 v[52:55], v11 offset:3072
    ds_read_b128 v[56:59], v11 offset:4096
    ds_read_b128 v[84:87], v10 offset:1024
    ds_read_b128 v[64:67], v11 offset:5120
    ds_read_b128 v[68:71], v11 offset:6144
    ds_read_b128 v[72:75], v11 offset:7168
    ds_read_b128 v[76:79], v11 offset:8192
    ds_read_b128 v[80:83], v11 offset:9216
    s_add_u32 s26, s26, 10240
    s_cmp_eq_u32 s26, 112640
    s_cselect_b32 s28, -102400, 0
    s_cselect_b32 s26, 0, s26
    s_cselect_b32 s28, s28, 10240
    v_add_u32 v11, s28, v11
    s_add_u32 s27, s27, 8192
    s_cmp_eq_u32 s27, 40960
    s_cselect_b32 s29, -32768, 0
    s_cselect_b32 s27, 0, s27
    s_cselect_b32 s29, s29, 8192
    v_add_u32 v10, s29, v10
    s_branch sequential_preLN__grouped_kv_mqa__dense_activation_silu__prompt_kernel_E_loop
.p2alignl 6, 0xBF800000
sequential_preLN__grouped_kv_mqa__dense_activation_silu__prompt_kernel_E_loop:
    s_waitcnt lgkmcnt(0)
    s_barrier
    ds_read_b128 v[108:111], v10 offset:0
    ds_read_b128 v[88:91], v11 offset:0
    ds_read_b128 v[92:95], v11 offset:1024
    v_mfma_f32_16x16x32_bf16 v[136:139], v[40:43], v[60:63], v[136:139]
    ds_read_b128 v[96:99], v11 offset:2048
    ds_read_b128 v[100:103], v11 offset:3072
    v_mfma_f32_16x16x32_bf16 v[140:143], v[44:47], v[60:63], v[140:143]
    ds_read_b128 v[104:107], v11 offset:4096
    ds_read_b128 v[132:135], v10 offset:1024
    ds_read_b128 v[112:115], v11 offset:5120
    v_mfma_f32_16x16x32_bf16 v[144:147], v[48:51], v[60:63], v[144:147]
    ds_read_b128 v[116:119], v11 offset:6144
    ds_read_b128 v[120:123], v11 offset:7168
    v_mfma_f32_16x16x32_bf16 v[148:151], v[52:55], v[60:63], v[148:151]
    ds_read_b128 v[124:127], v11 offset:8192
    ds_read_b128 v[128:131], v11 offset:9216
    v_mfma_f32_16x16x32_bf16 v[152:155], v[56:59], v[60:63], v[152:155]
    v_mfma_f32_16x16x32_bf16 v[136:139], v[64:67], v[84:87], v[136:139]
    s_add_u32 s26, s26, 10240
    s_cmp_eq_u32 s26, 112640
    s_cselect_b32 s28, -102400, 0
    s_cselect_b32 s26, 0, s26
    v_mfma_f32_16x16x32_bf16 v[140:143], v[68:71], v[84:87], v[140:143]
    s_cselect_b32 s28, s28, 10240
    v_add_u32 v11, s28, v11
    s_add_u32 s27, s27, 8192
    s_cmp_eq_u32 s27, 40960
    v_mfma_f32_16x16x32_bf16 v[144:147], v[72:75], v[84:87], v[144:147]
    s_cselect_b32 s29, -32768, 0
    s_cselect_b32 s27, 0, s27
    s_cselect_b32 s29, s29, 8192
    v_add_u32 v10, s29, v10
    v_mfma_f32_16x16x32_bf16 v[148:151], v[76:79], v[84:87], v[148:151]
    s_add_u32 s30, s30, 1
    s_cmp_lt_u32 s30, 27
    v_mfma_f32_16x16x32_bf16 v[152:155], v[80:83], v[84:87], v[152:155]
    s_cbranch_scc0 sequential_preLN__grouped_kv_mqa__dense_activation_silu__prompt_kernel_E_ldone
    s_waitcnt lgkmcnt(0)
    s_barrier
    ds_read_b128 v[60:63], v10 offset:0
    ds_read_b128 v[40:43], v11 offset:0
    ds_read_b128 v[44:47], v11 offset:1024
    v_mfma_f32_16x16x32_bf16 v[136:139], v[88:91], v[108:111], v[136:139]
    ds_read_b128 v[48:51], v11 offset:2048
    ds_read_b128 v[52:55], v11 offset:3072
    v_mfma_f32_16x16x32_bf16 v[140:143], v[92:95], v[108:111], v[140:143]
    ds_read_b128 v[56:59], v11 offset:4096
    ds_read_b128 v[84:87], v10 offset:1024
    ds_read_b128 v[64:67], v11 offset:5120
    v_mfma_f32_16x16x32_bf16 v[144:147], v[96:99], v[108:111], v[144:147]
    ds_read_b128 v[68:71], v11 offset:6144
    ds_read_b128 v[72:75], v11 offset:7168
    v_mfma_f32_16x16x32_bf16 v[148:151], v[100:103], v[108:111], v[148:151]
    ds_read_b128 v[76:79], v11 offset:8192
    ds_read_b128 v[80:83], v11 offset:9216
    v_mfma_f32_16x16x32_bf16 v[152:155], v[104:107], v[108:111], v[152:155]
    v_mfma_f32_16x16x32_bf16 v[136:139], v[112:115], v[132:135], v[136:139]
    s_add_u32 s26, s26, 10240
    s_cmp_eq_u32 s26, 112640
    s_cselect_b32 s28, -102400, 0
    s_cselect_b32 s26, 0, s26
    v_mfma_f32_16x16x32_bf16 v[140:143], v[116:119], v[132:135], v[140:143]
    s_cselect_b32 s28, s28, 10240
    v_add_u32 v11, s28, v11
    s_add_u32 s27, s27, 8192
    s_cmp_eq_u32 s27, 40960
    v_mfma_f32_16x16x32_bf16 v[144:147], v[120:123], v[132:135], v[144:147]
    s_cselect_b32 s29, -32768, 0
    s_cselect_b32 s27, 0, s27
    s_cselect_b32 s29, s29, 8192
    v_add_u32 v10, s29, v10
    v_mfma_f32_16x16x32_bf16 v[148:151], v[124:127], v[132:135], v[148:151]
    s_add_u32 s30, s30, 1
    s_cmp_lt_u32 s30, 27
    v_mfma_f32_16x16x32_bf16 v[152:155], v[128:131], v[132:135], v[152:155]
    s_cbranch_scc1 sequential_preLN__grouped_kv_mqa__dense_activation_silu__prompt_kernel_E_loop
sequential_preLN__grouped_kv_mqa__dense_activation_silu__prompt_kernel_E_ldone:
    s_waitcnt vmcnt(0) lgkmcnt(0)
    s_nop 4
    v_and_b32 v2, 15, v1
    v_and_b32 v5, 1, v9
    v_lshrrev_b32 v76, 1, v9
    v_mul_u32_u24 v3, 1280, v2
    v_lshl_add_u32 v3, v5, 5, v3
    v_lshl_add_u32 v3, v76, 4, v3
    v_lshlrev_b32 v76, 16, v38
    v_and_b32 v77, 0xffff0000, v38
    v_pk_add_f32 v[152:153], v[152:153], v[76:77]
    v_lshlrev_b32 v76, 16, v39
    v_and_b32 v77, 0xffff0000, v39
    v_pk_add_f32 v[154:155], v[154:155], v[76:77]
    v_cvt_pk_bf16_f32 v88, v152, v153
    v_cvt_pk_bf16_f32 v89, v154, v155
    buffer_store_dwordx2 v[88:89], v8, s[8:11], s47 offen offset:128
    v_lshlrev_b32 v76, 16, v30
    v_and_b32 v77, 0xffff0000, v30
    v_pk_add_f32 v[136:137], v[136:137], v[76:77]
    v_lshlrev_b32 v76, 16, v31
    v_and_b32 v77, 0xffff0000, v31
    v_pk_add_f32 v[138:139], v[138:139], v[76:77]
    v_cvt_pk_bf16_f32 v80, v136, v137
    v_cvt_pk_bf16_f32 v81, v138, v139
    v_lshlrev_b32 v76, 16, v32
    v_and_b32 v77, 0xffff0000, v32
    v_pk_add_f32 v[140:141], v[140:141], v[76:77]
    v_lshlrev_b32 v76, 16, v33
    v_and_b32 v77, 0xffff0000, v33
    v_pk_add_f32 v[142:143], v[142:143], v[76:77]
    v_cvt_pk_bf16_f32 v82, v140, v141
    v_cvt_pk_bf16_f32 v83, v142, v143
    s_nop 1
    v_permlane16_swap_b32 v80, v82
    v_permlane16_swap_b32 v81, v83
    buffer_store_dwordx4 v[80:83], v3, s[8:11], s47 offen offset:0
    v_lshlrev_b32 v76, 16, v34
    v_and_b32 v77, 0xffff0000, v34
    v_pk_add_f32 v[144:145], v[144:145], v[76:77]
    v_lshlrev_b32 v76, 16, v35
    v_and_b32 v77, 0xffff0000, v35
    v_pk_add_f32 v[146:147], v[146:147], v[76:77]
    v_cvt_pk_bf16_f32 v84, v144, v145
    v_cvt_pk_bf16_f32 v85, v146, v147
    v_lshlrev_b32 v76, 16, v36
    v_and_b32 v77, 0xffff0000, v36
    v_pk_add_f32 v[148:149], v[148:149], v[76:77]
    v_lshlrev_b32 v76, 16, v37
    v_and_b32 v77, 0xffff0000, v37
    v_pk_add_f32 v[150:151], v[150:151], v[76:77]
    v_cvt_pk_bf16_f32 v86, v148, v149
    v_cvt_pk_bf16_f32 v87, v150, v151
    s_nop 1
    v_permlane16_swap_b32 v84, v86
    v_permlane16_swap_b32 v85, v87
    buffer_store_dwordx4 v[84:87], v3, s[8:11], s47 offen offset:64
    s_waitcnt vmcnt(0)
sequential_preLN__grouped_kv_mqa__dense_activation_silu__prompt_kernel_end:
    s_endpgm
.section .rodata,"a"
.p2align 6
.amdhsa_kernel sequential_preLN__grouped_kv_mqa__dense_activation_silu__prompt_kernel
  .amdhsa_next_free_vgpr 168
  .amdhsa_next_free_sgpr 102
  .amdhsa_accum_offset 168
  .amdhsa_group_segment_fixed_size 0
  .amdhsa_kernarg_size 88
  .amdhsa_user_sgpr_count 2
  .amdhsa_user_sgpr_kernarg_segment_ptr 1
  .amdhsa_system_sgpr_workgroup_id_x 1
.end_amdhsa_kernel
```
